```python
import torch

def _softmax(x, axis=-1):
    return torch.softmax(x, dim=axis)
def _gelu(x):
    return torch.nn.functional.gelu(x, approximate="tanh")
def _silu(x):
    return torch.nn.functional.silu(x)
def _sigmoid(x):
    return torch.sigmoid(x)
def _layernorm(x, axis=-1, eps=1e-5):
    m = x.mean(dim=axis, keepdim=True)
    v = x.var(dim=axis, keepdim=True, unbiased=False)
    return (x - m) / torch.sqrt(v + eps)
def _scatter_add(tgt, idx, src, axis=0):
    return tgt.clone().index_add_(axis, idx, src)
def _segment_sum(src, seg, n):
    out = torch.zeros((n,) + src.shape[1:], dtype=src.dtype)
    return out.index_add_(0, seg, src)
def _pad(x, pw):
    flat = tuple(v for pair in reversed(pw) for v in pair)
    return torch.nn.functional.pad(x, flat)

kernel_name = 'gated_mix__mha_block_cached__gqa_block_cached__decode'

def setup_inputs():

    _w = (lambda a: (lambda t: t.to(torch.bfloat16) if t.is_floating_point() else t)(torch.as_tensor(a)))
    def _A_setup():
        B, Sq, D = 1, 1, 448
        H, Sk, Dh = 16, 8192, 256
        return {
            "x": _w((lambda *s: torch.randn(*s, dtype=torch.bfloat16) * 0.05)(B, Sq, D)),
            "k_cache": _w((lambda *s: torch.randn(*s, dtype=torch.bfloat16) * 3.2)(B, H, Sk, Dh)),
            "v_cache": _w((lambda *s: torch.randn(*s, dtype=torch.bfloat16) * 0.1)(B, H, Sk, Dh)),
            "wq": _w((lambda *s: torch.randn(*s, dtype=torch.bfloat16) * 3.2)(D, H * Dh) * (D ** -0.5)),
            "wo": _w((lambda *s: torch.randn(*s, dtype=torch.bfloat16) * 0.1)(H * Dh, D) * ((H * Dh) ** -0.5)),
        }
    _A_in = _A_setup()

    def _B_setup():
        B, Sq, D = 1, 1, 448
        Hq, Hkv, Sk, Dh = 16, 8, 8192, 256
        assert Hq % Hkv == 0, (Hq, Hkv)
        return {
            "x": _w((lambda *s: torch.randn(*s, dtype=torch.bfloat16) * 0.05)(B, Sq, D)),
            "k_cache": _w((lambda *s: torch.randn(*s, dtype=torch.bfloat16) * 3.2)(B, Hkv, Sk, Dh)),
            "v_cache": _w((lambda *s: torch.randn(*s, dtype=torch.bfloat16) * 0.05)(B, Hkv, Sk, Dh)),
            "wq": _w((lambda *s: torch.randn(*s, dtype=torch.bfloat16) * 3.2)(D, Hq * Dh) * (D ** -0.5)),
            "wo": _w((lambda *s: torch.randn(*s, dtype=torch.bfloat16) * 0.05)(Hq * Dh, D) * ((Hq * Dh) ** -0.5)),
        }
    _B_in = _B_setup()

    return {
        "A_x": _A_in["x"],
        "A_k_cache": _A_in["k_cache"],
        "A_v_cache": _A_in["v_cache"],
        "A_wq": _A_in["wq"],
        "A_wo": _A_in["wo"],
        "B_x": _B_in["x"],
        "B_k_cache": _B_in["k_cache"],
        "B_v_cache": _B_in["v_cache"],
        "B_wq": _B_in["wq"],
        "B_wo": _B_in["wo"],
        "gate_w": _w((lambda *s: torch.randn(*s, dtype=torch.bfloat16) * 0.1)(448) * 16.0),
    }

def reference(A_x, A_k_cache, A_v_cache, A_wq, A_wo, B_x, B_k_cache, B_v_cache, B_wq, B_wo, gate_w):
    def _A_ref(x, k_cache, v_cache, wq, wo):
        B, Sq, D = x.shape
        H, Dh = 16, 256
        q = (lambda x, *d: x.permute(*d))((x @ wq).reshape(B, Sq, H, Dh), 0, 2, 1, 3)
        scores = torch.einsum("bhqd,bhkd->bhqk", q, k_cache) * (Dh ** -0.5)
        p = _softmax(scores, axis=-1)
        o = torch.einsum("bhqk,bhkd->bhqd", p, v_cache)
        return (lambda x, *d: x.permute(*d))(o, 0, 2, 1, 3).reshape(B, Sq, H * Dh) @ wo

    def _B_ref(x, k_cache, v_cache, wq, wo):
        B, Sq, D = x.shape
        Hq, Dh = 16, 256
        Hkv = k_cache.shape[1]
        rep = Hq // Hkv
        q = (lambda x, *d: x.permute(*d))((x @ wq).reshape(B, Sq, Hq, Dh), 0, 2, 1, 3)
        k = (lambda x, n, axis: torch.repeat_interleave(x, n, dim=axis))(k_cache, rep, axis=1)
        v = (lambda x, n, axis: torch.repeat_interleave(x, n, dim=axis))(v_cache, rep, axis=1)
        scores = torch.einsum("bhqd,bhkd->bhqk", q, k) * (Dh ** -0.5)
        p = _softmax(scores, axis=-1)
        o = torch.einsum("bhqk,bhkd->bhqd", p, v)
        return (lambda x, *d: x.permute(*d))(o, 0, 2, 1, 3).reshape(B, Sq, Hq * Dh) @ wo

    x = A_x
    g = _sigmoid((x * gate_w).sum(-1, keepdims=True))
    a = _A_ref(x, A_k_cache, A_v_cache, A_wq, A_wo)
    b = _B_ref(x, B_k_cache, B_v_cache, B_wq, B_wo)
    return g * a + (1 - g) * b
```

```asm
; @launch grid=(256,1,1) block=(768,1,1) lds=29184
.amdgcn_target "amdgcn-amd-amdhsa--gfx950"
.text
.globl gated_mix__mha_block_cached__gqa_block_cached__decode_kernel
.p2align 8
.type gated_mix__mha_block_cached__gqa_block_cached__decode_kernel,@function
gated_mix__mha_block_cached__gqa_block_cached__decode_kernel:
    s_cmp_ge_u32 s2, 256
    s_cbranch_scc1 L_end
    s_load_dwordx16 s[4:19], s[0:1], 0
    s_and_b32 s3, s2, 7
    s_lshr_b32 s2, s2, 3
    s_lshl_b32 s3, s3, 5
    s_add_u32 s2, s2, s3
    s_load_dwordx8 s[20:27], s[0:1], 64
    s_load_dwordx4 s[28:31], s[0:1], 96
    s_bfe_u32 s93, s2, 0x40001
    s_lshl_b32 s93, s93, 4
    s_lshr_b32 s3, s2, 5
    s_lshl1_add_u32 s93, s3, s93
    s_and_b32 s3, s2, 1
    s_add_u32 s93, s93, s3
    s_lshr_b32 s3, s2, 1
    s_and_b32 s3, s3, 16
    s_xor_b32 s93, s93, s3
    s_lshl_b32 s3, s2, 1
    s_and_b32 s3, s3, 128
    s_xor_b32 s93, s93, s3
    s_mov_b32 s92, s2
    v_lshrrev_b32 v1, 6, v0
    v_and_b32 v0, 63, v0
    v_readfirstlane_b32 s3, v1
    s_nop 0
    s_cmp_lt_u32 s3, 4
    s_cbranch_scc1 L_helper
    s_sub_u32 s3, s3, 4
    v_lshrrev_b32 v2, 4, v0
    v_and_b32 v3, 15, v0
    v_lshlrev_b32 v2, 9, v2
    v_lshl_or_b32 v1, v3, 4, v2
    s_add_u32 s80, s3, s93
    s_and_b32 s80, s80, 7
    s_lshl_b32 s79, s80, 12
    s_lshl_b32 s77, s92, 17
    s_add_u32 s77, s77, s79
    s_mov_b32 s53, 0x8000
    s_mov_b32 s54, 0x10000
    s_mov_b32 s55, 0x18000
    s_mov_b32 s56, 0x20000
    s_mov_b32 s57, 0x28000
    s_mov_b32 s58, 0x30000
    s_mov_b32 s59, 0x38000
    s_mov_b32 s34, 0x19000
    s_mov_b32 s35, 0x20000
    s_mov_b32 s38, 0x19000
    s_mov_b32 s39, 0x20000
    s_waitcnt lgkmcnt(0)
    s_add_u32 s32, s16, s77
    s_addc_u32 s33, s17, 0
    s_add_u32 s36, s18, s77
    s_addc_u32 s37, s19, 0
    buffer_load_dwordx4 v[40:43], v1, s[32:35], 0 offen offset:0 nt
    buffer_load_dwordx4 v[44:47], v1, s[32:35], 0 offen offset:256 nt
    buffer_load_dwordx4 v[48:51], v1, s[32:35], 0 offen offset:2048 nt
    s_barrier
    s_lshr_b32 s81, s93, 4
    s_lshl_b32 s78, s81, 22
    s_and_b32 s76, s93, 15
    s_mul_i32 s76, s76, 262144
    s_add_u32 s76, s76, s78
    s_add_u32 s76, s76, s79
    s_add_u32 s78, s78, 229376
    s_add_u32 s40, s6, s76
    s_addc_u32 s41, s7, 0
    s_mov_b32 s42, 0x31000
    s_mov_b32 s43, 0x20000
    s_add_u32 s44, s8, s76
    s_addc_u32 s45, s9, 0
    s_mov_b32 s46, 0x31000
    s_mov_b32 s47, 0x20000
    s_add_u32 s60, s6, s78
    s_addc_u32 s61, s7, 0
    s_mov_b32 s62, 0x3c8000
    s_mov_b32 s63, 0x20000
    s_add_u32 s64, s8, s78
    s_addc_u32 s65, s9, 0
    s_mov_b32 s66, 0x3c8000
    s_mov_b32 s67, 0x20000
    s_mul_i32 s81, s81, 4352
    s_add_u32 s81, s81, 65536
    s_mov_b32 s48, s30
    s_mov_b32 s49, s31
    s_mov_b32 s50, 0x800000
    s_mov_b32 s51, 0x20000
    s_mul_i32 s75, s93, 1152
    s_add_u32 s75, s75, 4194304
    v_and_b32 v2, 1, v0
    v_lshlrev_b32 v2, 4, v2
    v_mov_b32 v3, 0xffff
    v_lshlrev_b32 v2, v2, v3
    v_bfe_u32 v3, v0, 1, 2
    v_cmp_eq_u32 vcc, 0, v3
    s_nop 1
    v_cndmask_b32 v8, 0, v2, vcc
    v_cmp_eq_u32 vcc, 1, v3
    s_nop 1
    v_cndmask_b32 v9, 0, v2, vcc
    v_cmp_eq_u32 vcc, 2, v3
    s_nop 1
    v_cndmask_b32 v10, 0, v2, vcc
    v_cmp_eq_u32 vcc, 3, v3
    s_nop 1
    v_cndmask_b32 v11, 0, v2, vcc
    s_mov_b32 s82, 0x3db8aa3b
    v_mov_b32 v2, 0
    v_mov_b32 v3, 1
    s_and_b32 s76, s2, 0x13
    s_cmp_eq_u32 s76, 3
    s_cbranch_scc1 L_swa
    s_waitcnt vmcnt(2)
    buffer_load_dwordx4 v[52:55], v1, s[32:35], 0 offen offset:2304 nt
    s_waitcnt vmcnt(2)
    buffer_load_dwordx4 v[56:59], v1, s[32:35], s53 offen offset:0 nt
    s_waitcnt vmcnt(2)
    buffer_load_dwordx4 v[60:63], v1, s[32:35], s53 offen offset:256 nt
    s_waitcnt vmcnt(2)
    buffer_load_dwordx4 v[64:67], v1, s[32:35], s53 offen offset:2048 nt
    s_waitcnt vmcnt(2)
    buffer_load_dwordx4 v[68:71], v1, s[32:35], s53 offen offset:2304 nt
    s_waitcnt vmcnt(2)
    buffer_load_dwordx4 v[72:75], v1, s[32:35], s54 offen offset:0 nt
    s_waitcnt vmcnt(2)
    buffer_load_dwordx4 v[76:79], v1, s[32:35], s54 offen offset:256 nt
    s_waitcnt vmcnt(2)
    buffer_load_dwordx4 v[80:83], v1, s[32:35], s54 offen offset:2048 nt
    s_waitcnt vmcnt(2)
    buffer_load_dwordx4 v[84:87], v1, s[32:35], s54 offen offset:2304 nt
    s_waitcnt vmcnt(2)
    buffer_load_dwordx4 v[88:91], v1, s[32:35], s55 offen offset:0 nt
    s_waitcnt vmcnt(2)
    buffer_load_dwordx4 v[92:95], v1, s[32:35], s55 offen offset:256 nt
    s_waitcnt vmcnt(2)
    buffer_load_dwordx4 v[96:99], v1, s[32:35], s55 offen offset:2048 nt
    s_waitcnt vmcnt(2)
    buffer_load_dwordx4 v[100:103], v1, s[32:35], s55 offen offset:2304 nt
    s_mov_b64 exec, 1
    ds_add_u32 v2, v3 offset:3880
    s_mov_b64 exec, -1
    s_waitcnt vmcnt(2)
    buffer_load_dwordx4 v[104:107], v1, s[36:39], 0 offen offset:0 nt
    s_waitcnt vmcnt(2)
    buffer_load_dwordx4 v[108:111], v1, s[36:39], 0 offen offset:256 nt
    s_waitcnt vmcnt(2)
    buffer_load_dwordx4 v[112:115], v1, s[36:39], 0 offen offset:2048 nt
    s_waitcnt vmcnt(2)
    buffer_load_dwordx4 v[116:119], v1, s[36:39], 0 offen offset:2304 nt
    s_waitcnt vmcnt(2)
    buffer_load_dwordx4 v[120:123], v1, s[36:39], s53 offen offset:0 nt
    s_waitcnt vmcnt(2)
    buffer_load_dwordx4 v[124:127], v1, s[36:39], s53 offen offset:256 nt
    s_waitcnt vmcnt(2)
    buffer_load_dwordx4 v[128:131], v1, s[36:39], s53 offen offset:2048 nt
    s_waitcnt vmcnt(2)
    buffer_load_dwordx4 v[132:135], v1, s[36:39], s53 offen offset:2304 nt
    s_waitcnt vmcnt(2)
    buffer_load_dwordx4 v[136:139], v1, s[36:39], s54 offen offset:0 nt
    s_waitcnt vmcnt(2)
    buffer_load_dwordx4 v[140:143], v1, s[36:39], s54 offen offset:256 nt
    s_waitcnt vmcnt(2)
    buffer_load_dwordx4 v[144:147], v1, s[36:39], s54 offen offset:2048 nt
    s_waitcnt vmcnt(2)
    buffer_load_dwordx4 v[148:151], v1, s[36:39], s54 offen offset:2304 nt
    s_waitcnt vmcnt(2)
    buffer_load_dwordx4 v[152:155], v1, s[36:39], s55 offen offset:0 nt
    s_waitcnt vmcnt(2)
    buffer_load_dwordx4 v[156:159], v1, s[36:39], s55 offen offset:256 nt
    s_waitcnt vmcnt(2)
    buffer_load_dwordx4 v[160:163], v1, s[36:39], s55 offen offset:2048 nt
    s_waitcnt vmcnt(2)
    buffer_load_dwordx4 v[164:167], v1, s[36:39], s55 offen offset:2304 nt
    s_branch L_swj
L_swa:
    buffer_load_dwordx4 v[52:55], v1, s[32:35], 0 offen offset:2304 nt
    s_waitcnt vmcnt(3)
    buffer_load_dwordx4 v[56:59], v1, s[32:35], s53 offen offset:0 nt
    s_waitcnt vmcnt(3)
    buffer_load_dwordx4 v[60:63], v1, s[32:35], s53 offen offset:256 nt
    s_waitcnt vmcnt(3)
    buffer_load_dwordx4 v[64:67], v1, s[32:35], s53 offen offset:2048 nt
    s_waitcnt vmcnt(3)
    buffer_load_dwordx4 v[68:71], v1, s[32:35], s53 offen offset:2304 nt
    s_waitcnt vmcnt(3)
    buffer_load_dwordx4 v[72:75], v1, s[32:35], s54 offen offset:0 nt
    s_waitcnt vmcnt(3)
    buffer_load_dwordx4 v[76:79], v1, s[32:35], s54 offen offset:256 nt
    s_waitcnt vmcnt(3)
    buffer_load_dwordx4 v[80:83], v1, s[32:35], s54 offen offset:2048 nt
    s_waitcnt vmcnt(3)
    buffer_load_dwordx4 v[84:87], v1, s[32:35], s54 offen offset:2304 nt
    s_waitcnt vmcnt(3)
    buffer_load_dwordx4 v[88:91], v1, s[32:35], s55 offen offset:0 nt
    s_waitcnt vmcnt(3)
    buffer_load_dwordx4 v[92:95], v1, s[32:35], s55 offen offset:256 nt
    s_waitcnt vmcnt(3)
    buffer_load_dwordx4 v[96:99], v1, s[32:35], s55 offen offset:2048 nt
    s_waitcnt vmcnt(3)
    buffer_load_dwordx4 v[100:103], v1, s[32:35], s55 offen offset:2304 nt
    s_mov_b64 exec, 1
    ds_add_u32 v2, v3 offset:3880
    s_mov_b64 exec, -1
    s_waitcnt vmcnt(3)
    buffer_load_dwordx4 v[104:107], v1, s[36:39], 0 offen offset:0 nt
    s_waitcnt vmcnt(3)
    buffer_load_dwordx4 v[108:111], v1, s[36:39], 0 offen offset:256 nt
    s_waitcnt vmcnt(3)
    buffer_load_dwordx4 v[112:115], v1, s[36:39], 0 offen offset:2048 nt
    s_waitcnt vmcnt(3)
    buffer_load_dwordx4 v[116:119], v1, s[36:39], 0 offen offset:2304 nt
    s_waitcnt vmcnt(3)
    buffer_load_dwordx4 v[120:123], v1, s[36:39], s53 offen offset:0 nt
    s_waitcnt vmcnt(3)
    buffer_load_dwordx4 v[124:127], v1, s[36:39], s53 offen offset:256 nt
    s_waitcnt vmcnt(3)
    buffer_load_dwordx4 v[128:131], v1, s[36:39], s53 offen offset:2048 nt
    s_waitcnt vmcnt(3)
    buffer_load_dwordx4 v[132:135], v1, s[36:39], s53 offen offset:2304 nt
    s_waitcnt vmcnt(3)
    buffer_load_dwordx4 v[136:139], v1, s[36:39], s54 offen offset:0 nt
    s_waitcnt vmcnt(2)
    buffer_load_dwordx4 v[140:143], v1, s[36:39], s54 offen offset:256 nt
    s_waitcnt vmcnt(2)
    buffer_load_dwordx4 v[144:147], v1, s[36:39], s54 offen offset:2048 nt
    s_waitcnt vmcnt(2)
    buffer_load_dwordx4 v[148:151], v1, s[36:39], s54 offen offset:2304 nt
    s_waitcnt vmcnt(2)
    buffer_load_dwordx4 v[152:155], v1, s[36:39], s55 offen offset:0 nt
    s_waitcnt vmcnt(2)
    buffer_load_dwordx4 v[156:159], v1, s[36:39], s55 offen offset:256 nt
    s_waitcnt vmcnt(2)
    buffer_load_dwordx4 v[160:163], v1, s[36:39], s55 offen offset:2048 nt
    s_waitcnt vmcnt(2)
    buffer_load_dwordx4 v[164:167], v1, s[36:39], s55 offen offset:2304 nt
L_swj:
    s_mov_b32 s83, 3200000
L_sq_w:
    ds_read_b32 v3, v2 offset:3844
    s_waitcnt lgkmcnt(0)
    v_readfirstlane_b32 s76, v3
    s_sub_u32 s83, s83, 1
    s_cbranch_scc1 L_sq_g
    s_cmp_lg_u32 s76, 0
    s_cbranch_scc1 L_sq_g
    s_sleep 1
    s_branch L_sq_w
L_sq_g:
    v_and_b32 v2, 15, v0
    v_lshlrev_b32 v2, 4, v2
    ds_read_b128 v[16:19], v2 offset:0
    ds_read_b128 v[20:23], v2 offset:256
    ds_read_b128 v[24:27], v2 offset:512
    ds_read_b128 v[28:31], v2 offset:768
    s_waitcnt lgkmcnt(0)
    v_dot2_f32_bf16 v2, v40, v16, 0
    v_dot2_f32_bf16 v3, v40, v24, 0
    v_dot2_f32_bf16 v2, v41, v17, v2
    v_dot2_f32_bf16 v3, v41, v25, v3
    v_dot2_f32_bf16 v2, v42, v18, v2
    v_dot2_f32_bf16 v3, v42, v26, v3
    v_dot2_f32_bf16 v2, v43, v19, v2
    v_dot2_f32_bf16 v3, v43, v27, v3
    v_dot2_f32_bf16 v2, v44, v20, v2
    v_dot2_f32_bf16 v3, v44, v28, v3
    v_dot2_f32_bf16 v2, v45, v21, v2
    v_dot2_f32_bf16 v3, v45, v29, v3
    v_dot2_f32_bf16 v2, v46, v22, v2
    v_dot2_f32_bf16 v3, v46, v30, v3
    v_dot2_f32_bf16 v2, v47, v23, v2
    v_dot2_f32_bf16 v3, v47, v31, v3
    s_waitcnt vmcnt(2)
    buffer_load_dwordx4 v[40:43], v1, s[40:43], 0 offen offset:0 nt
    s_waitcnt vmcnt(2)
    buffer_load_dwordx4 v[44:47], v1, s[40:43], 0 offen offset:256 nt
    v_dot2_f32_bf16 v4, v48, v16, 0
    v_dot2_f32_bf16 v5, v48, v24, 0
    v_dot2_f32_bf16 v4, v49, v17, v4
    v_add_f32_dpp v32, v2, v2 row_ror:8 row_mask:0xf bank_mask:0xf
    v_dot2_f32_bf16 v5, v49, v25, v5
    v_dot2_f32_bf16 v4, v50, v18, v4
    v_dot2_f32_bf16 v5, v50, v26, v5
    v_add_f32_dpp v32, v3, v3 row_ror:8 row_mask:0xf bank_mask:0xc
    v_dot2_f32_bf16 v4, v51, v19, v4
    v_dot2_f32_bf16 v5, v51, v27, v5
    v_dot2_f32_bf16 v4, v52, v20, v4
    v_add_f32_dpp v32, v32, v32 quad_perm:[1,0,3,2] row_mask:0xf bank_mask:0xf
    v_dot2_f32_bf16 v5, v52, v28, v5
    v_dot2_f32_bf16 v4, v53, v21, v4
    v_dot2_f32_bf16 v5, v53, v29, v5
    v_add_f32_dpp v32, v32, v32 quad_perm:[2,3,0,1] row_mask:0xf bank_mask:0xf
    v_dot2_f32_bf16 v4, v54, v22, v4
    v_dot2_f32_bf16 v5, v54, v30, v5
    v_dot2_f32_bf16 v4, v55, v23, v4
    v_add_f32_dpp v32, v32, v32 row_half_mirror row_mask:0xf bank_mask:0xf
    v_dot2_f32_bf16 v5, v55, v31, v5
    s_waitcnt vmcnt(2)
    buffer_load_dwordx4 v[48:51], v1, s[40:43], 0 offen offset:2048 nt
    s_waitcnt vmcnt(2)
    buffer_load_dwordx4 v[52:55], v1, s[40:43], 0 offen offset:2304 nt
    v_dot2_f32_bf16 v2, v56, v16, 0
    v_dot2_f32_bf16 v3, v56, v24, 0
    v_dot2_f32_bf16 v2, v57, v17, v2
    v_add_f32_dpp v33, v4, v4 row_ror:8 row_mask:0xf bank_mask:0xf
    v_dot2_f32_bf16 v3, v57, v25, v3
    v_dot2_f32_bf16 v2, v58, v18, v2
    v_dot2_f32_bf16 v3, v58, v26, v3
    v_add_f32_dpp v33, v5, v5 row_ror:8 row_mask:0xf bank_mask:0xc
    v_dot2_f32_bf16 v2, v59, v19, v2
    v_dot2_f32_bf16 v3, v59, v27, v3
    v_dot2_f32_bf16 v2, v60, v20, v2
    v_add_f32_dpp v33, v33, v33 quad_perm:[1,0,3,2] row_mask:0xf bank_mask:0xf
    v_dot2_f32_bf16 v3, v60, v28, v3
    v_dot2_f32_bf16 v2, v61, v21, v2
    v_dot2_f32_bf16 v3, v61, v29, v3
    v_add_f32_dpp v33, v33, v33 quad_perm:[2,3,0,1] row_mask:0xf bank_mask:0xf
    v_dot2_f32_bf16 v2, v62, v22, v2
    v_dot2_f32_bf16 v3, v62, v30, v3
    v_dot2_f32_bf16 v2, v63, v23, v2
    v_add_f32_dpp v33, v33, v33 row_half_mirror row_mask:0xf bank_mask:0xf
    v_dot2_f32_bf16 v3, v63, v31, v3
    v_dot2_f32_bf16 v4, v64, v16, 0
    v_dot2_f32_bf16 v5, v64, v24, 0
    v_dot2_f32_bf16 v4, v65, v17, v4
    v_add_f32_dpp v34, v2, v2 row_ror:8 row_mask:0xf bank_mask:0xf
    v_dot2_f32_bf16 v5, v65, v25, v5
    v_dot2_f32_bf16 v4, v66, v18, v4
    v_dot2_f32_bf16 v5, v66, v26, v5
    v_add_f32_dpp v34, v3, v3 row_ror:8 row_mask:0xf bank_mask:0xc
    v_dot2_f32_bf16 v4, v67, v19, v4
    v_dot2_f32_bf16 v5, v67, v27, v5
    v_dot2_f32_bf16 v4, v68, v20, v4
    v_add_f32_dpp v34, v34, v34 quad_perm:[1,0,3,2] row_mask:0xf bank_mask:0xf
    v_dot2_f32_bf16 v5, v68, v28, v5
    v_dot2_f32_bf16 v4, v69, v21, v4
    v_dot2_f32_bf16 v5, v69, v29, v5
    v_add_f32_dpp v34, v34, v34 quad_perm:[2,3,0,1] row_mask:0xf bank_mask:0xf
    v_dot2_f32_bf16 v4, v70, v22, v4
    v_dot2_f32_bf16 v5, v70, v30, v5
    v_dot2_f32_bf16 v4, v71, v23, v4
    v_add_f32_dpp v34, v34, v34 row_half_mirror row_mask:0xf bank_mask:0xf
    v_dot2_f32_bf16 v5, v71, v31, v5
    s_waitcnt vmcnt(2)
    buffer_load_dwordx4 v[56:59], v1, s[40:43], s53 offen offset:0 nt
    v_dot2_f32_bf16 v2, v72, v16, 0
    v_dot2_f32_bf16 v3, v72, v24, 0
    v_dot2_f32_bf16 v2, v73, v17, v2
    v_add_f32_dpp v35, v4, v4 row_ror:8 row_mask:0xf bank_mask:0xf
    v_dot2_f32_bf16 v3, v73, v25, v3
    v_dot2_f32_bf16 v2, v74, v18, v2
    v_dot2_f32_bf16 v3, v74, v26, v3
    v_add_f32_dpp v35, v5, v5 row_ror:8 row_mask:0xf bank_mask:0xc
    v_dot2_f32_bf16 v2, v75, v19, v2
    v_dot2_f32_bf16 v3, v75, v27, v3
    v_dot2_f32_bf16 v2, v76, v20, v2
    v_add_f32_dpp v35, v35, v35 quad_perm:[1,0,3,2] row_mask:0xf bank_mask:0xf
    v_dot2_f32_bf16 v3, v76, v28, v3
    v_dot2_f32_bf16 v2, v77, v21, v2
    v_dot2_f32_bf16 v3, v77, v29, v3
    v_add_f32_dpp v35, v35, v35 quad_perm:[2,3,0,1] row_mask:0xf bank_mask:0xf
    v_dot2_f32_bf16 v2, v78, v22, v2
    v_dot2_f32_bf16 v3, v78, v30, v3
    v_dot2_f32_bf16 v2, v79, v23, v2
    v_add_f32_dpp v35, v35, v35 row_half_mirror row_mask:0xf bank_mask:0xf
    v_dot2_f32_bf16 v3, v79, v31, v3
    v_dot2_f32_bf16 v4, v80, v16, 0
    v_dot2_f32_bf16 v5, v80, v24, 0
    v_dot2_f32_bf16 v4, v81, v17, v4
    v_add_f32_dpp v36, v2, v2 row_ror:8 row_mask:0xf bank_mask:0xf
    v_dot2_f32_bf16 v5, v81, v25, v5
    v_dot2_f32_bf16 v4, v82, v18, v4
    v_dot2_f32_bf16 v5, v82, v26, v5
    v_add_f32_dpp v36, v3, v3 row_ror:8 row_mask:0xf bank_mask:0xc
    v_dot2_f32_bf16 v4, v83, v19, v4
    v_dot2_f32_bf16 v5, v83, v27, v5
    v_dot2_f32_bf16 v4, v84, v20, v4
    v_add_f32_dpp v36, v36, v36 quad_perm:[1,0,3,2] row_mask:0xf bank_mask:0xf
    v_dot2_f32_bf16 v5, v84, v28, v5
    v_dot2_f32_bf16 v4, v85, v21, v4
    v_dot2_f32_bf16 v5, v85, v29, v5
    v_add_f32_dpp v36, v36, v36 quad_perm:[2,3,0,1] row_mask:0xf bank_mask:0xf
    v_dot2_f32_bf16 v4, v86, v22, v4
    v_dot2_f32_bf16 v5, v86, v30, v5
    v_dot2_f32_bf16 v4, v87, v23, v4
    v_add_f32_dpp v36, v36, v36 row_half_mirror row_mask:0xf bank_mask:0xf
    v_dot2_f32_bf16 v5, v87, v31, v5
    s_waitcnt vmcnt(2)
    buffer_load_dwordx4 v[60:63], v1, s[40:43], s53 offen offset:256 nt
    v_dot2_f32_bf16 v2, v88, v16, 0
    v_dot2_f32_bf16 v3, v88, v24, 0
    v_dot2_f32_bf16 v2, v89, v17, v2
    v_add_f32_dpp v37, v4, v4 row_ror:8 row_mask:0xf bank_mask:0xf
    v_dot2_f32_bf16 v3, v89, v25, v3
    v_dot2_f32_bf16 v2, v90, v18, v2
    v_dot2_f32_bf16 v3, v90, v26, v3
    v_add_f32_dpp v37, v5, v5 row_ror:8 row_mask:0xf bank_mask:0xc
    v_dot2_f32_bf16 v2, v91, v19, v2
    v_dot2_f32_bf16 v3, v91, v27, v3
    v_dot2_f32_bf16 v2, v92, v20, v2
    v_add_f32_dpp v37, v37, v37 quad_perm:[1,0,3,2] row_mask:0xf bank_mask:0xf
    v_dot2_f32_bf16 v3, v92, v28, v3
    v_dot2_f32_bf16 v2, v93, v21, v2
    v_dot2_f32_bf16 v3, v93, v29, v3
    v_add_f32_dpp v37, v37, v37 quad_perm:[2,3,0,1] row_mask:0xf bank_mask:0xf
    v_dot2_f32_bf16 v2, v94, v22, v2
    v_dot2_f32_bf16 v3, v94, v30, v3
    v_dot2_f32_bf16 v2, v95, v23, v2
    v_add_f32_dpp v37, v37, v37 row_half_mirror row_mask:0xf bank_mask:0xf
    v_dot2_f32_bf16 v3, v95, v31, v3
    v_dot2_f32_bf16 v4, v96, v16, 0
    v_dot2_f32_bf16 v5, v96, v24, 0
    v_dot2_f32_bf16 v4, v97, v17, v4
    v_add_f32_dpp v38, v2, v2 row_ror:8 row_mask:0xf bank_mask:0xf
    v_dot2_f32_bf16 v5, v97, v25, v5
    v_dot2_f32_bf16 v4, v98, v18, v4
    v_dot2_f32_bf16 v5, v98, v26, v5
    v_add_f32_dpp v38, v3, v3 row_ror:8 row_mask:0xf bank_mask:0xc
    v_dot2_f32_bf16 v4, v99, v19, v4
    v_dot2_f32_bf16 v5, v99, v27, v5
    v_dot2_f32_bf16 v4, v100, v20, v4
    v_add_f32_dpp v38, v38, v38 quad_perm:[1,0,3,2] row_mask:0xf bank_mask:0xf
    v_dot2_f32_bf16 v5, v100, v28, v5
    v_dot2_f32_bf16 v4, v101, v21, v4
    v_dot2_f32_bf16 v5, v101, v29, v5
    v_add_f32_dpp v38, v38, v38 quad_perm:[2,3,0,1] row_mask:0xf bank_mask:0xf
    v_dot2_f32_bf16 v4, v102, v22, v4
    v_dot2_f32_bf16 v5, v102, v30, v5
    v_dot2_f32_bf16 v4, v103, v23, v4
    v_add_f32_dpp v38, v38, v38 row_half_mirror row_mask:0xf bank_mask:0xf
    v_dot2_f32_bf16 v5, v103, v31, v5
    s_waitcnt vmcnt(2)
    buffer_load_dwordx4 v[64:67], v1, s[40:43], s53 offen offset:2048 nt
    v_add_f32_dpp v39, v4, v4 row_ror:8 row_mask:0xf bank_mask:0xf
    v_add_f32_dpp v39, v5, v5 row_ror:8 row_mask:0xf bank_mask:0xc
    s_nop 1
    v_add_f32_dpp v39, v39, v39 quad_perm:[1,0,3,2] row_mask:0xf bank_mask:0xf
    s_nop 1
    v_add_f32_dpp v39, v39, v39 quad_perm:[2,3,0,1] row_mask:0xf bank_mask:0xf
    s_nop 1
    v_add_f32_dpp v39, v39, v39 row_half_mirror row_mask:0xf bank_mask:0xf
    v_cvt_pk_bf16_f32 v32, v32, v32
    v_cvt_pk_bf16_f32 v33, v33, v33
    v_cvt_pk_bf16_f32 v34, v34, v34
    v_cvt_pk_bf16_f32 v35, v35, v35
    v_cvt_pk_bf16_f32 v36, v36, v36
    v_cvt_pk_bf16_f32 v37, v37, v37
    v_cvt_pk_bf16_f32 v38, v38, v38
    v_cvt_pk_bf16_f32 v39, v39, v39
    v_and_b32 v32, 0xffff0000, v32
    v_and_b32 v33, 0xffff0000, v33
    v_and_b32 v34, 0xffff0000, v34
    v_and_b32 v35, 0xffff0000, v35
    v_and_b32 v36, 0xffff0000, v36
    v_and_b32 v37, 0xffff0000, v37
    v_and_b32 v38, 0xffff0000, v38
    v_and_b32 v39, 0xffff0000, v39
    v_max3_f32 v6, v32, v33, v34
    v_max3_f32 v6, v6, v35, v36
    v_max3_f32 v6, v6, v37, v38
    v_max_f32 v6, v6, v39
    v_mov_b32 v2, v6
    s_nop 1
    v_permlane16_swap_b32 v2, v6
    v_max_f32 v6, v2, v6
    v_mov_b32 v2, v6
    s_nop 1
    v_permlane32_swap_b32 v2, v6
    v_max_f32 v6, v2, v6
    v_mul_f32 v6, s82, v6
    v_and_b32 v5, 8, v0
    v_lshlrev_b32 v5, 2, v5
    s_lshl_b32 s76, s3, 2
    v_add_u32 v5, s76, v5
    v_mov_b32 v3, 0
    v_mov_b32 v4, 1
    v_fma_f32 v32, v32, s82, -v6
    v_fma_f32 v33, v33, s82, -v6
    v_fma_f32 v34, v34, s82, -v6
    v_fma_f32 v35, v35, s82, -v6
    v_fma_f32 v36, v36, s82, -v6
    v_fma_f32 v37, v37, s82, -v6
    v_fma_f32 v38, v38, s82, -v6
    v_fma_f32 v39, v39, s82, -v6
    v_exp_f32 v32, v32
    v_exp_f32 v33, v33
    v_exp_f32 v34, v34
    v_exp_f32 v35, v35
    v_exp_f32 v36, v36
    v_exp_f32 v37, v37
    v_exp_f32 v38, v38
    v_exp_f32 v39, v39
    s_waitcnt vmcnt(2)
    buffer_load_dwordx4 v[68:71], v1, s[40:43], s53 offen offset:2304 nt
    v_add_f32 v7, v32, v33
    v_add_f32 v7, v7, v34
    v_add_f32 v7, v7, v35
    v_add_f32 v7, v7, v36
    v_add_f32 v7, v7, v37
    v_add_f32 v7, v7, v38
    v_add_f32 v7, v7, v39
    v_cvt_pk_bf16_f32 v32, v32, v32
    v_cvt_pk_bf16_f32 v33, v33, v33
    v_cvt_pk_bf16_f32 v34, v34, v34
    v_cvt_pk_bf16_f32 v35, v35, v35
    v_cvt_pk_bf16_f32 v36, v36, v36
    v_cvt_pk_bf16_f32 v37, v37, v37
    v_cvt_pk_bf16_f32 v38, v38, v38
    v_cvt_pk_bf16_f32 v39, v39, v39
    v_mov_b32 v2, v7
    s_nop 1
    v_permlane16_swap_b32 v2, v7
    v_add_f32 v7, v2, v7
    v_mov_b32 v2, v7
    s_nop 1
    v_permlane32_swap_b32 v2, v7
    v_add_f32 v7, v2, v7
    s_mov_b64 exec, 0x101
    ds_write_b32 v5, v6 offset:3584
    ds_write_b32 v5, v7 offset:3712
    s_mov_b64 exec, -1
    v_and_b32 v2, 15, v0
    v_and_b32 v5, 16, v0
    v_lshl_or_b32 v2, v2, 5, v5
    v_lshrrev_b32 v5, 5, v0
    v_lshl_or_b32 v2, v5, 13, v2
    s_lshl_b32 s76, s3, 10
    v_add_u32 v2, s76, v2
    v_and_b32 v12, v32, v8
    v_and_b32 v13, v32, v9
    v_and_b32 v14, v32, v10
    v_and_b32 v15, v32, v11
    s_nop 1
    v_mfma_f32_16x16x32_bf16 v[16:19], v[12:15], v[104:107], 0
    v_mfma_f32_16x16x32_bf16 v[20:23], v[12:15], v[108:111], 0
    v_and_b32 v12, v33, v8
    v_and_b32 v13, v33, v9
    v_and_b32 v14, v33, v10
    v_and_b32 v15, v33, v11
    s_nop 1
    v_mfma_f32_16x16x32_bf16 v[16:19], v[12:15], v[112:115], v[16:19]
    v_mfma_f32_16x16x32_bf16 v[20:23], v[12:15], v[116:119], v[20:23]
    v_and_b32 v12, v34, v8
    v_and_b32 v13, v34, v9
    v_and_b32 v14, v34, v10
    v_and_b32 v15, v34, v11
    s_nop 1
    v_mfma_f32_16x16x32_bf16 v[16:19], v[12:15], v[120:123], v[16:19]
    v_mfma_f32_16x16x32_bf16 v[20:23], v[12:15], v[124:127], v[20:23]
    v_and_b32 v12, v35, v8
    v_and_b32 v13, v35, v9
    v_and_b32 v14, v35, v10
    v_and_b32 v15, v35, v11
    s_nop 1
    v_mfma_f32_16x16x32_bf16 v[16:19], v[12:15], v[128:131], v[16:19]
    v_mfma_f32_16x16x32_bf16 v[20:23], v[12:15], v[132:135], v[20:23]
    v_and_b32 v12, v36, v8
    v_and_b32 v13, v36, v9
    v_and_b32 v14, v36, v10
    v_and_b32 v15, v36, v11
    s_nop 1
    v_mfma_f32_16x16x32_bf16 v[16:19], v[12:15], v[136:139], v[16:19]
    v_mfma_f32_16x16x32_bf16 v[20:23], v[12:15], v[140:143], v[20:23]
    v_and_b32 v12, v37, v8
    v_and_b32 v13, v37, v9
    v_and_b32 v14, v37, v10
    v_and_b32 v15, v37, v11
    s_waitcnt vmcnt(2)
    buffer_load_dwordx4 v[72:75], v1, s[40:43], s54 offen offset:0 nt
    v_mfma_f32_16x16x32_bf16 v[16:19], v[12:15], v[144:147], v[16:19]
    v_mfma_f32_16x16x32_bf16 v[20:23], v[12:15], v[148:151], v[20:23]
    v_and_b32 v12, v38, v8
    v_and_b32 v13, v38, v9
    v_and_b32 v14, v38, v10
    v_and_b32 v15, v38, v11
    s_nop 1
    v_mfma_f32_16x16x32_bf16 v[16:19], v[12:15], v[152:155], v[16:19]
    v_mfma_f32_16x16x32_bf16 v[20:23], v[12:15], v[156:159], v[20:23]
    v_and_b32 v12, v39, v8
    v_and_b32 v13, v39, v9
    v_and_b32 v14, v39, v10
    v_and_b32 v15, v39, v11
    s_nop 1
    v_mfma_f32_16x16x32_bf16 v[16:19], v[12:15], v[160:163], v[16:19]
    v_mfma_f32_16x16x32_bf16 v[20:23], v[12:15], v[164:167], v[20:23]
    s_nop 6
    ds_write_b128 v2, v[16:19] offset:4096
    ds_write_b128 v2, v[20:23] offset:4608
    s_mov_b64 exec, 1
    ds_add_u32 v3, v4 offset:3856
    s_mov_b64 exec, -1
    v_and_b32 v2, 15, v0
    v_lshlrev_b32 v2, 4, v2
    ds_read_b128 v[104:107], v2 offset:1024
    ds_read_b128 v[108:111], v2 offset:1280
    v_mov_b32 v157, 0
    ds_read_b32 v3, v157 offset:3884
    v_mov_b32 v156, 1
    v_mov_b32 v158, s81
    v_mov_b32 v144, 0x3f803f80
    v_mov_b32 v145, 0x3f803f80
    v_mov_b32 v146, 0x3f803f80
    v_mov_b32 v147, 0x3f803f80
    v_and_b32 v161, 15, v0
    v_and_b32 v162, 16, v0
    v_lshlrev_b32 v163, 3, v0
    v_lshl_or_b32 v161, v161, 5, v162
    s_lshl_b32 s76, s3, 10
    v_add_u32 v161, s76, v161
    v_lshlrev_b32 v162, 4, v0
    s_waitcnt lgkmcnt(0)
    v_readfirstlane_b32 s74, v3
    s_mov_b32 s83, 400000
    v_dot2_f32_bf16 v2, v40, v104, 0
    v_dot2_f32_bf16 v2, v41, v105, v2
    v_dot2_f32_bf16 v2, v42, v106, v2
    v_dot2_f32_bf16 v2, v43, v107, v2
    v_dot2_f32_bf16 v2, v44, v108, v2
    v_dot2_f32_bf16 v2, v45, v109, v2
    v_dot2_f32_bf16 v2, v46, v110, v2
    v_dot2_f32_bf16 v2, v47, v111, v2
    s_waitcnt vmcnt(2)
    buffer_load_dwordx4 v[76:79], v1, s[40:43], s54 offen offset:256 nt
    v_dot2_f32_bf16 v4, v48, v104, 0
    v_dot2_f32_bf16 v4, v49, v105, v4
    v_add_f32_dpp v24, v2, v2 row_ror:8 row_mask:0xf bank_mask:0xf
    v_dot2_f32_bf16 v4, v50, v106, v4
    v_dot2_f32_bf16 v4, v51, v107, v4
    v_add_f32_dpp v24, v24, v24 quad_perm:[1,0,3,2] row_mask:0xf bank_mask:0xf
    v_dot2_f32_bf16 v4, v52, v108, v4
    v_dot2_f32_bf16 v4, v53, v109, v4
    v_add_f32_dpp v24, v24, v24 quad_perm:[2,3,0,1] row_mask:0xf bank_mask:0xf
    v_dot2_f32_bf16 v4, v54, v110, v4
    v_dot2_f32_bf16 v4, v55, v111, v4
    v_add_f32_dpp v24, v24, v24 row_half_mirror row_mask:0xf bank_mask:0xf
    v_dot2_f32_bf16 v2, v56, v104, 0
    v_dot2_f32_bf16 v2, v57, v105, v2
    v_add_f32_dpp v25, v4, v4 row_ror:8 row_mask:0xf bank_mask:0xf
    v_dot2_f32_bf16 v2, v58, v106, v2
    v_dot2_f32_bf16 v2, v59, v107, v2
    v_add_f32_dpp v25, v25, v25 quad_perm:[1,0,3,2] row_mask:0xf bank_mask:0xf
    v_dot2_f32_bf16 v2, v60, v108, v2
    v_dot2_f32_bf16 v2, v61, v109, v2
    v_add_f32_dpp v25, v25, v25 quad_perm:[2,3,0,1] row_mask:0xf bank_mask:0xf
    v_dot2_f32_bf16 v2, v62, v110, v2
    v_dot2_f32_bf16 v2, v63, v111, v2
    v_add_f32_dpp v25, v25, v25 row_half_mirror row_mask:0xf bank_mask:0xf
    s_waitcnt vmcnt(2)
    buffer_load_dwordx4 v[80:83], v1, s[40:43], s54 offen offset:2048 nt
    v_dot2_f32_bf16 v4, v64, v104, 0
    v_dot2_f32_bf16 v4, v65, v105, v4
    v_add_f32_dpp v26, v2, v2 row_ror:8 row_mask:0xf bank_mask:0xf
    v_dot2_f32_bf16 v4, v66, v106, v4
    v_dot2_f32_bf16 v4, v67, v107, v4
    v_add_f32_dpp v26, v26, v26 quad_perm:[1,0,3,2] row_mask:0xf bank_mask:0xf
    v_dot2_f32_bf16 v4, v68, v108, v4
    v_dot2_f32_bf16 v4, v69, v109, v4
    v_add_f32_dpp v26, v26, v26 quad_perm:[2,3,0,1] row_mask:0xf bank_mask:0xf
    v_dot2_f32_bf16 v4, v70, v110, v4
    v_dot2_f32_bf16 v4, v71, v111, v4
    v_add_f32_dpp v26, v26, v26 row_half_mirror row_mask:0xf bank_mask:0xf
    s_waitcnt vmcnt(2)
    buffer_load_dwordx4 v[84:87], v1, s[40:43], s54 offen offset:2304 nt
    s_waitcnt vmcnt(2)
    buffer_load_dwordx4 v[88:91], v1, s[40:43], s55 offen offset:0 nt
    v_dot2_f32_bf16 v2, v72, v104, 0
    v_dot2_f32_bf16 v2, v73, v105, v2
    v_add_f32_dpp v27, v4, v4 row_ror:8 row_mask:0xf bank_mask:0xf
    v_dot2_f32_bf16 v2, v74, v106, v2
    v_dot2_f32_bf16 v2, v75, v107, v2
    v_add_f32_dpp v27, v27, v27 quad_perm:[1,0,3,2] row_mask:0xf bank_mask:0xf
    v_dot2_f32_bf16 v2, v76, v108, v2
    v_dot2_f32_bf16 v2, v77, v109, v2
    v_add_f32_dpp v27, v27, v27 quad_perm:[2,3,0,1] row_mask:0xf bank_mask:0xf
    v_dot2_f32_bf16 v2, v78, v110, v2
    v_dot2_f32_bf16 v2, v79, v111, v2
    v_add_f32_dpp v27, v27, v27 row_half_mirror row_mask:0xf bank_mask:0xf
    s_waitcnt vmcnt(2)
    buffer_load_dwordx4 v[92:95], v1, s[40:43], s55 offen offset:256 nt
    s_waitcnt vmcnt(2)
    buffer_load_dwordx4 v[96:99], v1, s[40:43], s55 offen offset:2048 nt
    v_dot2_f32_bf16 v4, v80, v104, 0
    v_dot2_f32_bf16 v4, v81, v105, v4
    v_add_f32_dpp v28, v2, v2 row_ror:8 row_mask:0xf bank_mask:0xf
    v_dot2_f32_bf16 v4, v82, v106, v4
    v_dot2_f32_bf16 v4, v83, v107, v4
    v_add_f32_dpp v28, v28, v28 quad_perm:[1,0,3,2] row_mask:0xf bank_mask:0xf
    v_dot2_f32_bf16 v4, v84, v108, v4
    v_dot2_f32_bf16 v4, v85, v109, v4
    v_add_f32_dpp v28, v28, v28 quad_perm:[2,3,0,1] row_mask:0xf bank_mask:0xf
    v_dot2_f32_bf16 v4, v86, v110, v4
    v_dot2_f32_bf16 v4, v87, v111, v4
    v_add_f32_dpp v28, v28, v28 row_half_mirror row_mask:0xf bank_mask:0xf
    s_waitcnt vmcnt(2)
    buffer_load_dwordx4 v[100:103], v1, s[40:43], s55 offen offset:2304 nt
    s_waitcnt vmcnt(2)
    buffer_load_dwordx4 v[40:43], v1, s[40:43], s56 offen offset:0 nt
    v_dot2_f32_bf16 v2, v88, v104, 0
    v_dot2_f32_bf16 v2, v89, v105, v2
    v_add_f32_dpp v29, v4, v4 row_ror:8 row_mask:0xf bank_mask:0xf
    v_dot2_f32_bf16 v2, v90, v106, v2
    v_dot2_f32_bf16 v2, v91, v107, v2
    v_add_f32_dpp v29, v29, v29 quad_perm:[1,0,3,2] row_mask:0xf bank_mask:0xf
    v_dot2_f32_bf16 v2, v92, v108, v2
    v_dot2_f32_bf16 v2, v93, v109, v2
    v_add_f32_dpp v29, v29, v29 quad_perm:[2,3,0,1] row_mask:0xf bank_mask:0xf
    v_dot2_f32_bf16 v2, v94, v110, v2
    v_dot2_f32_bf16 v2, v95, v111, v2
    v_add_f32_dpp v29, v29, v29 row_half_mirror row_mask:0xf bank_mask:0xf
    s_waitcnt vmcnt(2)
    buffer_load_dwordx4 v[44:47], v1, s[40:43], s56 offen offset:256 nt
    s_waitcnt vmcnt(2)
    buffer_load_dwordx4 v[48:51], v1, s[40:43], s56 offen offset:2048 nt
    v_dot2_f32_bf16 v4, v96, v104, 0
    v_dot2_f32_bf16 v4, v97, v105, v4
    v_add_f32_dpp v30, v2, v2 row_ror:8 row_mask:0xf bank_mask:0xf
    v_dot2_f32_bf16 v4, v98, v106, v4
    v_dot2_f32_bf16 v4, v99, v107, v4
    v_add_f32_dpp v30, v30, v30 quad_perm:[1,0,3,2] row_mask:0xf bank_mask:0xf
    v_dot2_f32_bf16 v4, v100, v108, v4
    v_dot2_f32_bf16 v4, v101, v109, v4
    v_add_f32_dpp v30, v30, v30 quad_perm:[2,3,0,1] row_mask:0xf bank_mask:0xf
    v_dot2_f32_bf16 v4, v102, v110, v4
    v_dot2_f32_bf16 v4, v103, v111, v4
    v_add_f32_dpp v30, v30, v30 row_half_mirror row_mask:0xf bank_mask:0xf
    s_waitcnt vmcnt(2)
    buffer_load_dwordx4 v[52:55], v1, s[40:43], s56 offen offset:2304 nt
    s_waitcnt vmcnt(2)
    buffer_load_dwordx4 v[56:59], v1, s[40:43], s57 offen offset:0 nt
    v_dot2_f32_bf16 v2, v40, v104, 0
    v_dot2_f32_bf16 v2, v41, v105, v2
    v_add_f32_dpp v31, v4, v4 row_ror:8 row_mask:0xf bank_mask:0xf
    v_dot2_f32_bf16 v2, v42, v106, v2
    v_dot2_f32_bf16 v2, v43, v107, v2
    v_add_f32_dpp v31, v31, v31 quad_perm:[1,0,3,2] row_mask:0xf bank_mask:0xf
    v_dot2_f32_bf16 v2, v44, v108, v2
    v_dot2_f32_bf16 v2, v45, v109, v2
    v_add_f32_dpp v31, v31, v31 quad_perm:[2,3,0,1] row_mask:0xf bank_mask:0xf
    v_dot2_f32_bf16 v2, v46, v110, v2
    v_dot2_f32_bf16 v2, v47, v111, v2
    v_add_f32_dpp v31, v31, v31 row_half_mirror row_mask:0xf bank_mask:0xf
    s_waitcnt vmcnt(2)
    buffer_load_dwordx4 v[60:63], v1, s[40:43], s57 offen offset:256 nt
    s_waitcnt vmcnt(2)
    buffer_load_dwordx4 v[64:67], v1, s[40:43], s57 offen offset:2048 nt
    v_dot2_f32_bf16 v4, v48, v104, 0
    v_dot2_f32_bf16 v4, v49, v105, v4
    v_add_f32_dpp v32, v2, v2 row_ror:8 row_mask:0xf bank_mask:0xf
    v_dot2_f32_bf16 v4, v50, v106, v4
    v_dot2_f32_bf16 v4, v51, v107, v4
    v_add_f32_dpp v32, v32, v32 quad_perm:[1,0,3,2] row_mask:0xf bank_mask:0xf
    v_dot2_f32_bf16 v4, v52, v108, v4
    v_dot2_f32_bf16 v4, v53, v109, v4
    v_add_f32_dpp v32, v32, v32 quad_perm:[2,3,0,1] row_mask:0xf bank_mask:0xf
    v_dot2_f32_bf16 v4, v54, v110, v4
    v_dot2_f32_bf16 v4, v55, v111, v4
    v_add_f32_dpp v32, v32, v32 row_half_mirror row_mask:0xf bank_mask:0xf
    s_waitcnt vmcnt(2)
    buffer_load_dwordx4 v[68:71], v1, s[40:43], s57 offen offset:2304 nt
    s_waitcnt vmcnt(2)
    buffer_load_dwordx4 v[72:75], v1, s[40:43], s58 offen offset:0 nt
    v_dot2_f32_bf16 v2, v56, v104, 0
    v_dot2_f32_bf16 v2, v57, v105, v2
    v_add_f32_dpp v33, v4, v4 row_ror:8 row_mask:0xf bank_mask:0xf
    v_dot2_f32_bf16 v2, v58, v106, v2
    v_dot2_f32_bf16 v2, v59, v107, v2
    v_add_f32_dpp v33, v33, v33 quad_perm:[1,0,3,2] row_mask:0xf bank_mask:0xf
    v_dot2_f32_bf16 v2, v60, v108, v2
    v_dot2_f32_bf16 v2, v61, v109, v2
    v_add_f32_dpp v33, v33, v33 quad_perm:[2,3,0,1] row_mask:0xf bank_mask:0xf
    v_dot2_f32_bf16 v2, v62, v110, v2
    v_dot2_f32_bf16 v2, v63, v111, v2
    v_add_f32_dpp v33, v33, v33 row_half_mirror row_mask:0xf bank_mask:0xf
    s_waitcnt vmcnt(2)
    buffer_load_dwordx4 v[76:79], v1, s[40:43], s58 offen offset:256 nt
    s_waitcnt vmcnt(2)
    buffer_load_dwordx4 v[80:83], v1, s[40:43], s58 offen offset:2048 nt
    v_dot2_f32_bf16 v4, v64, v104, 0
    v_dot2_f32_bf16 v4, v65, v105, v4
    v_add_f32_dpp v34, v2, v2 row_ror:8 row_mask:0xf bank_mask:0xf
    v_dot2_f32_bf16 v4, v66, v106, v4
    v_dot2_f32_bf16 v4, v67, v107, v4
    v_add_f32_dpp v34, v34, v34 quad_perm:[1,0,3,2] row_mask:0xf bank_mask:0xf
    v_dot2_f32_bf16 v4, v68, v108, v4
    v_dot2_f32_bf16 v4, v69, v109, v4
    v_add_f32_dpp v34, v34, v34 quad_perm:[2,3,0,1] row_mask:0xf bank_mask:0xf
    v_dot2_f32_bf16 v4, v70, v110, v4
    v_dot2_f32_bf16 v4, v71, v111, v4
    v_add_f32_dpp v34, v34, v34 row_half_mirror row_mask:0xf bank_mask:0xf
    s_waitcnt vmcnt(2)
    buffer_load_dwordx4 v[84:87], v1, s[40:43], s58 offen offset:2304 nt
    s_waitcnt vmcnt(2)
    buffer_load_dwordx4 v[88:91], v1, s[44:47], 0 offen offset:0 nt
    v_dot2_f32_bf16 v2, v72, v104, 0
    v_dot2_f32_bf16 v2, v73, v105, v2
    v_add_f32_dpp v35, v4, v4 row_ror:8 row_mask:0xf bank_mask:0xf
    v_dot2_f32_bf16 v2, v74, v106, v2
    v_dot2_f32_bf16 v2, v75, v107, v2
    v_add_f32_dpp v35, v35, v35 quad_perm:[1,0,3,2] row_mask:0xf bank_mask:0xf
    v_dot2_f32_bf16 v2, v76, v108, v2
    v_dot2_f32_bf16 v2, v77, v109, v2
    v_add_f32_dpp v35, v35, v35 quad_perm:[2,3,0,1] row_mask:0xf bank_mask:0xf
    v_dot2_f32_bf16 v2, v78, v110, v2
    v_dot2_f32_bf16 v2, v79, v111, v2
    v_add_f32_dpp v35, v35, v35 row_half_mirror row_mask:0xf bank_mask:0xf
    s_waitcnt vmcnt(2)
    buffer_load_dwordx4 v[92:95], v1, s[44:47], 0 offen offset:256 nt
    s_waitcnt vmcnt(2)
    buffer_load_dwordx4 v[96:99], v1, s[44:47], 0 offen offset:2048 nt
    v_dot2_f32_bf16 v4, v80, v104, 0
    v_dot2_f32_bf16 v4, v81, v105, v4
    v_add_f32_dpp v36, v2, v2 row_ror:8 row_mask:0xf bank_mask:0xf
    v_dot2_f32_bf16 v4, v82, v106, v4
    v_dot2_f32_bf16 v4, v83, v107, v4
    v_add_f32_dpp v36, v36, v36 quad_perm:[1,0,3,2] row_mask:0xf bank_mask:0xf
    v_dot2_f32_bf16 v4, v84, v108, v4
    v_dot2_f32_bf16 v4, v85, v109, v4
    v_add_f32_dpp v36, v36, v36 quad_perm:[2,3,0,1] row_mask:0xf bank_mask:0xf
    v_dot2_f32_bf16 v4, v86, v110, v4
    v_dot2_f32_bf16 v4, v87, v111, v4
    v_add_f32_dpp v36, v36, v36 row_half_mirror row_mask:0xf bank_mask:0xf
    s_nop 1
    v_add_f32_dpp v37, v4, v4 row_ror:8 row_mask:0xf bank_mask:0xf
    s_nop 1
    v_add_f32_dpp v37, v37, v37 quad_perm:[1,0,3,2] row_mask:0xf bank_mask:0xf
    s_nop 1
    v_add_f32_dpp v37, v37, v37 quad_perm:[2,3,0,1] row_mask:0xf bank_mask:0xf
    s_nop 1
    v_add_f32_dpp v37, v37, v37 row_half_mirror row_mask:0xf bank_mask:0xf
    v_cvt_pk_bf16_f32 v24, v24, v24
    v_cvt_pk_bf16_f32 v25, v25, v25
    v_cvt_pk_bf16_f32 v26, v26, v26
    v_cvt_pk_bf16_f32 v27, v27, v27
    v_cvt_pk_bf16_f32 v28, v28, v28
    v_cvt_pk_bf16_f32 v29, v29, v29
    v_cvt_pk_bf16_f32 v30, v30, v30
    v_cvt_pk_bf16_f32 v31, v31, v31
    v_cvt_pk_bf16_f32 v32, v32, v32
    v_cvt_pk_bf16_f32 v33, v33, v33
    v_cvt_pk_bf16_f32 v34, v34, v34
    v_cvt_pk_bf16_f32 v35, v35, v35
    v_cvt_pk_bf16_f32 v36, v36, v36
    v_cvt_pk_bf16_f32 v37, v37, v37
    v_and_b32 v24, 0xffff0000, v24
    v_and_b32 v25, 0xffff0000, v25
    v_and_b32 v26, 0xffff0000, v26
    v_and_b32 v27, 0xffff0000, v27
    v_and_b32 v28, 0xffff0000, v28
    v_and_b32 v29, 0xffff0000, v29
    v_and_b32 v30, 0xffff0000, v30
    v_and_b32 v31, 0xffff0000, v31
    v_and_b32 v32, 0xffff0000, v32
    v_and_b32 v33, 0xffff0000, v33
    v_and_b32 v34, 0xffff0000, v34
    v_and_b32 v35, 0xffff0000, v35
    v_and_b32 v36, 0xffff0000, v36
    v_and_b32 v37, 0xffff0000, v37
    s_waitcnt vmcnt(2)
    buffer_load_dwordx4 v[100:103], v1, s[44:47], 0 offen offset:2304 nt
    v_max3_f32 v6, v24, v25, v26
    v_max3_f32 v6, v6, v27, v28
    v_max3_f32 v6, v6, v29, v30
    v_max3_f32 v6, v6, v31, v32
    v_max3_f32 v6, v6, v33, v34
    v_max3_f32 v6, v6, v35, v36
    v_max_f32 v6, v6, v37
    v_mov_b32 v2, v6
    s_nop 1
    v_permlane16_swap_b32 v2, v6
    v_max_f32 v6, v2, v6
    v_mov_b32 v2, v6
    s_nop 1
    v_permlane32_swap_b32 v2, v6
    v_max_f32 v6, v2, v6
    v_mul_f32 v6, s82, v6
    v_and_b32 v5, 8, v0
    v_lshlrev_b32 v5, 2, v5
    s_lshl_b32 s76, s3, 2
    v_add_u32 v5, s76, v5
    v_mov_b32 v3, 0
    v_mov_b32 v4, 1
    s_mov_b64 exec, 1
    ds_add_u32 v3, v4 offset:3852
    s_mov_b64 exec, -1
    v_fma_f32 v24, v24, s82, -v6
    v_fma_f32 v25, v25, s82, -v6
    v_fma_f32 v26, v26, s82, -v6
    v_fma_f32 v27, v27, s82, -v6
    v_fma_f32 v28, v28, s82, -v6
    v_fma_f32 v29, v29, s82, -v6
    v_fma_f32 v30, v30, s82, -v6
    v_fma_f32 v31, v31, s82, -v6
    v_fma_f32 v32, v32, s82, -v6
    v_fma_f32 v33, v33, s82, -v6
    v_fma_f32 v34, v34, s82, -v6
    v_fma_f32 v35, v35, s82, -v6
    v_fma_f32 v36, v36, s82, -v6
    v_fma_f32 v37, v37, s82, -v6
    v_exp_f32 v24, v24
    v_exp_f32 v25, v25
    v_exp_f32 v26, v26
    v_exp_f32 v27, v27
    v_exp_f32 v28, v28
    v_exp_f32 v29, v29
    v_exp_f32 v30, v30
    v_exp_f32 v31, v31
    v_exp_f32 v32, v32
    v_exp_f32 v33, v33
    v_exp_f32 v34, v34
    v_exp_f32 v35, v35
    v_exp_f32 v36, v36
    v_exp_f32 v37, v37
    s_waitcnt vmcnt(2)
    buffer_load_dwordx4 v[40:43], v1, s[44:47], s53 offen offset:0 nt
    v_add_f32 v148, v24, v25
    v_add_f32 v148, v148, v26
    v_add_f32 v148, v148, v27
    v_add_f32 v148, v148, v28
    v_add_f32 v148, v148, v29
    v_add_f32 v148, v148, v30
    v_add_f32 v148, v148, v31
    v_add_f32 v148, v148, v32
    v_add_f32 v148, v148, v33
    v_add_f32 v148, v148, v34
    v_add_f32 v148, v148, v35
    v_add_f32 v148, v148, v36
    v_add_f32 v148, v148, v37
    v_cvt_pk_bf16_f32 v24, v24, v24
    v_cvt_pk_bf16_f32 v25, v25, v25
    v_cvt_pk_bf16_f32 v26, v26, v26
    v_cvt_pk_bf16_f32 v27, v27, v27
    v_cvt_pk_bf16_f32 v28, v28, v28
    v_cvt_pk_bf16_f32 v29, v29, v29
    v_cvt_pk_bf16_f32 v30, v30, v30
    v_cvt_pk_bf16_f32 v31, v31, v31
    v_cvt_pk_bf16_f32 v32, v32, v32
    v_cvt_pk_bf16_f32 v33, v33, v33
    v_cvt_pk_bf16_f32 v34, v34, v34
    v_cvt_pk_bf16_f32 v35, v35, v35
    v_cvt_pk_bf16_f32 v36, v36, v36
    v_cvt_pk_bf16_f32 v37, v37, v37
    v_mov_b32 v2, v148
    s_nop 1
    v_permlane16_swap_b32 v2, v148
    v_add_f32 v148, v2, v148
    v_mov_b32 v2, v148
    s_nop 1
    v_permlane32_swap_b32 v2, v148
    v_add_f32 v148, v2, v148
    v_mov_b32 v149, 0
    v_mov_b32 v150, 0
    v_mov_b32 v151, 0
    v_and_b32 v12, v24, v8
    v_and_b32 v13, v24, v9
    v_and_b32 v14, v24, v10
    v_and_b32 v15, v24, v11
    s_nop 1
    v_mfma_f32_16x16x32_bf16 v[16:19], v[12:15], v[88:91], 0
    v_mfma_f32_16x16x32_bf16 v[20:23], v[12:15], v[92:95], 0
    v_and_b32 v12, v25, v8
    v_and_b32 v13, v25, v9
    v_and_b32 v14, v25, v10
    v_and_b32 v15, v25, v11
    s_waitcnt vmcnt(2)
    buffer_load_dwordx4 v[44:47], v1, s[44:47], s53 offen offset:256 nt
    s_waitcnt vmcnt(2)
    buffer_load_dwordx4 v[48:51], v1, s[44:47], s53 offen offset:2048 nt
    v_mfma_f32_16x16x32_bf16 v[16:19], v[12:15], v[96:99], v[16:19]
    v_mfma_f32_16x16x32_bf16 v[20:23], v[12:15], v[100:103], v[20:23]
    v_and_b32 v12, v26, v8
    v_and_b32 v13, v26, v9
    v_and_b32 v14, v26, v10
    v_and_b32 v15, v26, v11
    s_waitcnt vmcnt(2)
    buffer_load_dwordx4 v[52:55], v1, s[44:47], s53 offen offset:2304 nt
    s_waitcnt vmcnt(2)
    buffer_load_dwordx4 v[56:59], v1, s[44:47], s54 offen offset:0 nt
    v_mfma_f32_16x16x32_bf16 v[16:19], v[12:15], v[40:43], v[16:19]
    v_mfma_f32_16x16x32_bf16 v[20:23], v[12:15], v[44:47], v[20:23]
    v_and_b32 v12, v27, v8
    v_and_b32 v13, v27, v9
    v_and_b32 v14, v27, v10
    v_and_b32 v15, v27, v11
    s_waitcnt vmcnt(2)
    buffer_load_dwordx4 v[60:63], v1, s[44:47], s54 offen offset:256 nt
    s_waitcnt vmcnt(2)
    buffer_load_dwordx4 v[64:67], v1, s[44:47], s54 offen offset:2048 nt
    v_mfma_f32_16x16x32_bf16 v[16:19], v[12:15], v[48:51], v[16:19]
    v_mfma_f32_16x16x32_bf16 v[20:23], v[12:15], v[52:55], v[20:23]
    v_and_b32 v12, v28, v8
    v_and_b32 v13, v28, v9
    v_and_b32 v14, v28, v10
    v_and_b32 v15, v28, v11
    s_waitcnt vmcnt(2)
    buffer_load_dwordx4 v[68:71], v1, s[44:47], s54 offen offset:2304 nt
    s_waitcnt vmcnt(2)
    buffer_load_dwordx4 v[72:75], v1, s[44:47], s55 offen offset:0 nt
    v_mfma_f32_16x16x32_bf16 v[16:19], v[12:15], v[56:59], v[16:19]
    v_mfma_f32_16x16x32_bf16 v[20:23], v[12:15], v[60:63], v[20:23]
    v_and_b32 v12, v29, v8
    v_and_b32 v13, v29, v9
    v_and_b32 v14, v29, v10
    v_and_b32 v15, v29, v11
    s_waitcnt vmcnt(2)
    buffer_load_dwordx4 v[76:79], v1, s[44:47], s55 offen offset:256 nt
    s_waitcnt vmcnt(2)
    buffer_load_dwordx4 v[80:83], v1, s[44:47], s55 offen offset:2048 nt
    v_mfma_f32_16x16x32_bf16 v[16:19], v[12:15], v[64:67], v[16:19]
    v_mfma_f32_16x16x32_bf16 v[20:23], v[12:15], v[68:71], v[20:23]
    v_and_b32 v12, v30, v8
    v_and_b32 v13, v30, v9
    v_and_b32 v14, v30, v10
    v_and_b32 v15, v30, v11
    s_waitcnt vmcnt(2)
    buffer_load_dwordx4 v[84:87], v1, s[44:47], s55 offen offset:2304 nt
    s_waitcnt vmcnt(2)
    buffer_load_dwordx4 v[88:91], v1, s[44:47], s56 offen offset:0 nt
    v_mfma_f32_16x16x32_bf16 v[16:19], v[12:15], v[72:75], v[16:19]
    v_mfma_f32_16x16x32_bf16 v[20:23], v[12:15], v[76:79], v[20:23]
    v_and_b32 v12, v31, v8
    v_and_b32 v13, v31, v9
    v_and_b32 v14, v31, v10
    v_and_b32 v15, v31, v11
    s_waitcnt vmcnt(2)
    buffer_load_dwordx4 v[92:95], v1, s[44:47], s56 offen offset:256 nt
    s_waitcnt vmcnt(2)
    buffer_load_dwordx4 v[96:99], v1, s[44:47], s56 offen offset:2048 nt
    v_mfma_f32_16x16x32_bf16 v[16:19], v[12:15], v[80:83], v[16:19]
    v_mfma_f32_16x16x32_bf16 v[20:23], v[12:15], v[84:87], v[20:23]
    v_and_b32 v12, v32, v8
    v_and_b32 v13, v32, v9
    v_and_b32 v14, v32, v10
    v_and_b32 v15, v32, v11
    s_waitcnt vmcnt(2)
    buffer_load_dwordx4 v[100:103], v1, s[44:47], s56 offen offset:2304 nt
    s_waitcnt vmcnt(2)
    buffer_load_dwordx4 v[40:43], v1, s[44:47], s57 offen offset:0 nt
    v_mfma_f32_16x16x32_bf16 v[16:19], v[12:15], v[88:91], v[16:19]
    v_mfma_f32_16x16x32_bf16 v[20:23], v[12:15], v[92:95], v[20:23]
    v_and_b32 v12, v33, v8
    v_and_b32 v13, v33, v9
    v_and_b32 v14, v33, v10
    v_and_b32 v15, v33, v11
    s_waitcnt vmcnt(2)
    buffer_load_dwordx4 v[44:47], v1, s[44:47], s57 offen offset:256 nt
    s_waitcnt vmcnt(2)
    buffer_load_dwordx4 v[48:51], v1, s[44:47], s57 offen offset:2048 nt
    v_mfma_f32_16x16x32_bf16 v[16:19], v[12:15], v[96:99], v[16:19]
    v_mfma_f32_16x16x32_bf16 v[20:23], v[12:15], v[100:103], v[20:23]
    v_and_b32 v12, v34, v8
    v_and_b32 v13, v34, v9
    v_and_b32 v14, v34, v10
    v_and_b32 v15, v34, v11
    s_waitcnt vmcnt(2)
    s_mov_b64 exec, 1
    ds_add_rtn_u32 v164, v157, v156 offset:3900
    s_mov_b64 exec, -1
    v_mov_b32 v166, 0x400000
    buffer_load_dwordx4 v[52:55], v1, s[44:47], s57 offen offset:2304 nt
    s_waitcnt vmcnt(2)
    s_waitcnt lgkmcnt(0)
    v_readfirstlane_b32 s76, v164
    s_mov_b64 exec, 1
    s_cmp_eq_u32 s76, 0
    s_cselect_b32 s80, 28672, 0
    s_cbranch_scc0 L_rql1
    global_atomic_add_x2 v[152:153], v158, v[156:157], s[30:31] sc0 sc1
    s_branch L_rqe1
L_rql1:
    buffer_load_dword v165, v166, s[60:63], 0 offen
L_rqe1:
    s_mov_b64 exec, -1
    buffer_load_dwordx4 v[56:59], v1, s[44:47], s58 offen offset:0 nt
    v_mfma_f32_16x16x32_bf16 v[16:19], v[12:15], v[40:43], v[16:19]
    v_mfma_f32_16x16x32_bf16 v[20:23], v[12:15], v[44:47], v[20:23]
    v_and_b32 v12, v35, v8
    v_and_b32 v13, v35, v9
    v_and_b32 v14, v35, v10
    v_and_b32 v15, v35, v11
    s_waitcnt vmcnt(3)
    buffer_load_dwordx4 v[60:63], v1, s[44:47], s58 offen offset:256 nt
    s_waitcnt vmcnt(3)
    buffer_load_dwordx4 v[64:67], v1, s[44:47], s58 offen offset:2048 nt
    v_mfma_f32_16x16x32_bf16 v[16:19], v[12:15], v[48:51], v[16:19]
    v_mfma_f32_16x16x32_bf16 v[20:23], v[12:15], v[52:55], v[20:23]
    v_and_b32 v12, v36, v8
    v_and_b32 v13, v36, v9
    v_and_b32 v14, v36, v10
    v_and_b32 v15, v36, v11
    s_waitcnt vmcnt(2)
    buffer_load_dwordx4 v[68:71], v1, s[44:47], s58 offen offset:2304 nt
    s_mov_b64 exec, 1
    ds_add_rtn_u32 v164, v157, v156 offset:3896
    s_mov_b64 exec, -1
    s_waitcnt vmcnt(2)
    s_waitcnt lgkmcnt(0)
    s_mov_b64 exec, 1
    v_lshrrev_b32 v3, 3, v164
    v_lshlrev_b32 v3, 2, v3
    s_cmp_eq_u32 s80, 0
    s_cbranch_scc1 L_rdp
L_tkp:
    v_readfirstlane_b32 s69, v153
    v_add_u32 v152, 1, v152
    v_mov_b32 v4, s80
    s_cmp_lg_u32 s69, s74
    s_cbranch_scc1 L_trp
L_tgp:
    ds_write_b32 v4, v152
L_rdp:
    ds_read_b32 v4, v3 offset:28672
    v_readfirstlane_b32 s77, v164
    v_readfirstlane_b32 s80, v3
    s_and_b32 s77, s77, 7
    s_add_u32 s80, s80, 28676
L_swp:
    s_waitcnt lgkmcnt(0)
    v_readfirstlane_b32 s68, v4
    s_nop 0
    s_sub_u32 s68, s68, 1
    s_cbranch_scc1 L_spp
L_sgp:
    s_min_u32 s76, s68, 32
    s_lshr_b32 s69, s76, 1
    s_lshl_b32 s69, s69, 6
    s_add_u32 s69, s69, s77
    s_and_b32 s76, s76, 1
    s_lshl1_add_u32 s76, s69, s76
    s_lshl_b32 s76, s76, 11
    s_cmp_ge_u32 s68, 32
    s_cselect_b32 s69, 9, s77
    s_cmp_eq_u32 s69, 0
    s_cselect_b32 s80, s80, 0
    s_cbranch_scc0 L_rql2
    global_atomic_add_x2 v[152:153], v158, v[156:157], s[30:31] sc0 sc1
    s_branch L_rqe2
L_rql2:
    buffer_load_dword v165, v166, s[60:63], 0 offen
L_rqe2:
    s_mov_b64 exec, -1
    v_add_u32 v159, s76, v1
    buffer_load_dwordx4 v[112:115], v159, s[60:63], 0 offen nt
    s_cmp_lt_u32 s68, 24
    s_cbranch_scc1 L_fap
    buffer_load_dwordx4 v[116:119], v159, s[60:63], 0 offen offset:256 nt
    buffer_load_dwordx4 v[120:123], v159, s[64:67], 0 offen nt
    buffer_load_dwordx4 v[124:127], v159, s[64:67], 0 offen offset:256 nt
L_fap:
    v_mfma_f32_16x16x32_bf16 v[16:19], v[12:15], v[56:59], v[16:19]
    v_mfma_f32_16x16x32_bf16 v[20:23], v[12:15], v[60:63], v[20:23]
    v_and_b32 v12, v37, v8
    v_and_b32 v13, v37, v9
    v_and_b32 v14, v37, v10
    v_and_b32 v15, v37, v11
    s_waitcnt vmcnt(5)
    s_cmp_ge_u32 s68, 24
    s_cbranch_scc1 L_fbp
    s_waitcnt vmcnt(3)
    buffer_load_dwordx4 v[116:119], v159, s[60:63], 0 offen offset:256 nt
    s_waitcnt vmcnt(3)
    buffer_load_dwordx4 v[120:123], v159, s[64:67], 0 offen nt
L_fbp:
    v_mfma_f32_16x16x32_bf16 v[16:19], v[12:15], v[64:67], v[16:19]
    v_mfma_f32_16x16x32_bf16 v[20:23], v[12:15], v[68:71], v[20:23]
    s_cmp_ge_u32 s68, 32
    s_cbranch_scc1 L_dend
    s_cmp_ge_u32 s68, 24
    s_cbranch_scc1 L_dloop
    s_waitcnt vmcnt(2)
    buffer_load_dwordx4 v[124:127], v159, s[64:67], 0 offen offset:256 nt
L_dloop:
    s_mov_b64 exec, 1
    ds_add_rtn_u32 v164, v157, v156 offset:3896
    s_mov_b64 exec, -1
    s_waitcnt vmcnt(2) lgkmcnt(0)
    s_mov_b64 exec, 1
    v_lshrrev_b32 v3, 3, v164
    v_lshlrev_b32 v3, 2, v3
    s_cmp_eq_u32 s80, 0
    s_cbranch_scc1 L_rdd0
L_tkd0:
    v_readfirstlane_b32 s69, v153
    v_add_u32 v152, 1, v152
    v_mov_b32 v4, s80
    s_cmp_lg_u32 s69, s74
    s_cbranch_scc1 L_trd0
L_tgd0:
    ds_write_b32 v4, v152
L_rdd0:
    ds_read_b32 v4, v3 offset:28672
    v_readfirstlane_b32 s77, v164
    v_readfirstlane_b32 s80, v3
    s_mov_b64 exec, -1
    v_dot2_f32_bf16 v160, v112, v104, 0
    v_dot2_f32_bf16 v160, v113, v105, v160
    v_dot2_f32_bf16 v160, v114, v106, v160
    v_dot2_f32_bf16 v160, v115, v107, v160
    v_dot2_f32_bf16 v160, v116, v108, v160
    v_dot2_f32_bf16 v160, v117, v109, v160
    v_dot2_f32_bf16 v160, v118, v110, v160
    v_dot2_f32_bf16 v160, v119, v111, v160
    s_mov_b64 exec, 1
    s_and_b32 s77, s77, 7
    s_add_u32 s80, s80, 28676
L_swd0:
    s_waitcnt lgkmcnt(0)
    v_readfirstlane_b32 s68, v4
    s_nop 0
    s_sub_u32 s68, s68, 1
    s_cbranch_scc1 L_spd0
L_sgd0:
    s_min_u32 s76, s68, 32
    s_lshr_b32 s69, s76, 1
    s_lshl_b32 s69, s69, 6
    s_add_u32 s69, s69, s77
    s_and_b32 s76, s76, 1
    s_lshl1_add_u32 s76, s69, s76
    s_lshl_b32 s76, s76, 11
    s_cmp_ge_u32 s68, 32
    s_cselect_b32 s69, 9, s77
    s_cmp_eq_u32 s69, 0
    s_cselect_b32 s80, s80, 0
    s_cbranch_scc0 L_rql3
    global_atomic_add_x2 v[152:153], v158, v[156:157], s[30:31] sc0 sc1
    s_branch L_rqe3
L_rql3:
    buffer_load_dword v165, v166, s[60:63], 0 offen
L_rqe3:
    s_mov_b64 exec, -1
    v_add_u32 v159, s76, v1
    buffer_load_dwordx4 v[128:131], v159, s[60:63], 0 offen nt
    s_cmp_lt_u32 s68, 24
    s_cbranch_scc1 L_fad0
    buffer_load_dwordx4 v[132:135], v159, s[60:63], 0 offen offset:256 nt
    buffer_load_dwordx4 v[136:139], v159, s[64:67], 0 offen nt
    buffer_load_dwordx4 v[140:143], v159, s[64:67], 0 offen offset:256 nt
L_fad0:
    v_add_f32_dpp v160, v160, v160 row_ror:8 row_mask:0xf bank_mask:0xf
    s_nop 1
    v_add_f32_dpp v160, v160, v160 quad_perm:[1,0,3,2] row_mask:0xf bank_mask:0xf
    s_nop 1
    v_add_f32_dpp v160, v160, v160 quad_perm:[2,3,0,1] row_mask:0xf bank_mask:0xf
    s_nop 1
    v_add_f32_dpp v160, v160, v160 row_half_mirror row_mask:0xf bank_mask:0xf
    v_cvt_pk_bf16_f32 v160, v160, v160
    v_and_b32 v160, 0xffff0000, v160
    v_fma_f32 v2, v160, s82, -v6
    v_cmp_lt_f32 vcc, 0, v2
    s_cbranch_vccnz L_rs0
L_rb0:
    v_exp_f32 v2, v2
    s_nop 0
    v_cvt_pk_bf16_f32 v2, v2, v2
    v_and_b32 v12, v2, v8
    v_and_b32 v13, v2, v9
    v_and_b32 v14, v2, v10
    v_and_b32 v15, v2, v11
    s_nop 1
    v_mfma_f32_16x16x32_bf16 v[148:151], v[12:15], v[144:147], v[148:151]
    s_waitcnt vmcnt(5)
    s_cmp_ge_u32 s68, 24
    s_cbranch_scc1 L_fbd0
    s_waitcnt vmcnt(3)
    buffer_load_dwordx4 v[132:135], v159, s[60:63], 0 offen offset:256 nt
    s_waitcnt vmcnt(3)
    buffer_load_dwordx4 v[136:139], v159, s[64:67], 0 offen nt
L_fbd0:
    v_mfma_f32_16x16x32_bf16 v[16:19], v[12:15], v[120:123], v[16:19]
    v_mfma_f32_16x16x32_bf16 v[20:23], v[12:15], v[124:127], v[20:23]
    s_cmp_ge_u32 s68, 32
    s_cbranch_scc1 L_dend
    s_cmp_ge_u32 s68, 24
    s_cbranch_scc1 L_dl1
    s_waitcnt vmcnt(2)
    buffer_load_dwordx4 v[140:143], v159, s[64:67], 0 offen offset:256 nt
L_dl1:
    s_mov_b64 exec, 1
    ds_add_rtn_u32 v164, v157, v156 offset:3896
    s_mov_b64 exec, -1
    s_waitcnt vmcnt(2) lgkmcnt(0)
    s_mov_b64 exec, 1
    v_lshrrev_b32 v3, 3, v164
    v_lshlrev_b32 v3, 2, v3
    s_cmp_eq_u32 s80, 0
    s_cbranch_scc1 L_rdd1
L_tkd1:
    v_readfirstlane_b32 s69, v153
    v_add_u32 v152, 1, v152
    v_mov_b32 v4, s80
    s_cmp_lg_u32 s69, s74
    s_cbranch_scc1 L_trd1
L_tgd1:
    ds_write_b32 v4, v152
L_rdd1:
    ds_read_b32 v4, v3 offset:28672
    v_readfirstlane_b32 s77, v164
    v_readfirstlane_b32 s80, v3
    s_mov_b64 exec, -1
    v_dot2_f32_bf16 v160, v128, v104, 0
    v_dot2_f32_bf16 v160, v129, v105, v160
    v_dot2_f32_bf16 v160, v130, v106, v160
    v_dot2_f32_bf16 v160, v131, v107, v160
    v_dot2_f32_bf16 v160, v132, v108, v160
    v_dot2_f32_bf16 v160, v133, v109, v160
    v_dot2_f32_bf16 v160, v134, v110, v160
    v_dot2_f32_bf16 v160, v135, v111, v160
    s_mov_b64 exec, 1
    s_and_b32 s77, s77, 7
    s_add_u32 s80, s80, 28676
L_swd1:
    s_waitcnt lgkmcnt(0)
    v_readfirstlane_b32 s68, v4
    s_nop 0
    s_sub_u32 s68, s68, 1
    s_cbranch_scc1 L_spd1
L_sgd1:
    s_min_u32 s76, s68, 32
    s_lshr_b32 s69, s76, 1
    s_lshl_b32 s69, s69, 6
    s_add_u32 s69, s69, s77
    s_and_b32 s76, s76, 1
    s_lshl1_add_u32 s76, s69, s76
    s_lshl_b32 s76, s76, 11
    s_cmp_ge_u32 s68, 32
    s_cselect_b32 s69, 9, s77
    s_cmp_eq_u32 s69, 0
    s_cselect_b32 s80, s80, 0
    s_cbranch_scc0 L_rql4
    global_atomic_add_x2 v[152:153], v158, v[156:157], s[30:31] sc0 sc1
    s_branch L_rqe4
L_rql4:
    buffer_load_dword v165, v166, s[60:63], 0 offen
L_rqe4:
    s_mov_b64 exec, -1
    v_add_u32 v159, s76, v1
    buffer_load_dwordx4 v[112:115], v159, s[60:63], 0 offen nt
    s_cmp_lt_u32 s68, 24
    s_cbranch_scc1 L_fad1
    buffer_load_dwordx4 v[116:119], v159, s[60:63], 0 offen offset:256 nt
    buffer_load_dwordx4 v[120:123], v159, s[64:67], 0 offen nt
    buffer_load_dwordx4 v[124:127], v159, s[64:67], 0 offen offset:256 nt
L_fad1:
    v_add_f32_dpp v160, v160, v160 row_ror:8 row_mask:0xf bank_mask:0xf
    s_nop 1
    v_add_f32_dpp v160, v160, v160 quad_perm:[1,0,3,2] row_mask:0xf bank_mask:0xf
    s_nop 1
    v_add_f32_dpp v160, v160, v160 quad_perm:[2,3,0,1] row_mask:0xf bank_mask:0xf
    s_nop 1
    v_add_f32_dpp v160, v160, v160 row_half_mirror row_mask:0xf bank_mask:0xf
    v_cvt_pk_bf16_f32 v160, v160, v160
    v_and_b32 v160, 0xffff0000, v160
    v_fma_f32 v2, v160, s82, -v6
    v_cmp_lt_f32 vcc, 0, v2
    s_cbranch_vccnz L_rs1
L_rb1:
    v_exp_f32 v2, v2
    s_nop 0
    v_cvt_pk_bf16_f32 v2, v2, v2
    v_and_b32 v12, v2, v8
    v_and_b32 v13, v2, v9
    v_and_b32 v14, v2, v10
    v_and_b32 v15, v2, v11
    s_nop 1
    v_mfma_f32_16x16x32_bf16 v[148:151], v[12:15], v[144:147], v[148:151]
    s_waitcnt vmcnt(5)
    s_cmp_ge_u32 s68, 24
    s_cbranch_scc1 L_fbd1
    s_waitcnt vmcnt(3)
    buffer_load_dwordx4 v[116:119], v159, s[60:63], 0 offen offset:256 nt
    s_waitcnt vmcnt(3)
    buffer_load_dwordx4 v[120:123], v159, s[64:67], 0 offen nt
L_fbd1:
    v_mfma_f32_16x16x32_bf16 v[16:19], v[12:15], v[136:139], v[16:19]
    v_mfma_f32_16x16x32_bf16 v[20:23], v[12:15], v[140:143], v[20:23]
    s_cmp_ge_u32 s68, 32
    s_cbranch_scc1 L_dend
    s_cmp_ge_u32 s68, 24
    s_cbranch_scc1 L_dloop
    s_waitcnt vmcnt(2)
    buffer_load_dwordx4 v[124:127], v159, s[64:67], 0 offen offset:256 nt
    s_branch L_dloop
L_dend:
    s_nop 2
    s_lshl_b32 s76, s3, 3
    v_mov_b32 v2, s76
    v_mov_b32 v7, v148
    s_mov_b32 s53, 0x03020105
    s_mov_b32 s54, 0x03020106
    s_mov_b32 s55, 0x03020107
    s_mov_b32 s56, 0xaaaaaaaa
    s_mov_b32 s57, 0xaaaaaaaa
    s_mov_b32 exec_hi, 0
    ds_write_b128 v161, v[16:19] offset:20480
    ds_write_b128 v161, v[20:23] offset:20992
    s_mov_b64 exec, 1
    ds_write_b64 v2, v[6:7] offset:3648
    ds_add_rtn_u32 v5, v157, v156 offset:3860
    s_mov_b64 exec, -1
L_mrg:
    ds_read_b128 v[72:75], v157 offset:3648
    ds_read_b128 v[76:79], v157 offset:3664
    ds_read_b128 v[80:83], v157 offset:3680
    ds_read_b128 v[84:87], v157 offset:3696
    ds_read_b128 v[40:43], v162 offset:20480
    ds_read_b128 v[44:47], v162 offset:21504
    ds_read_b128 v[48:51], v162 offset:22528
    ds_read_b128 v[52:55], v162 offset:23552
    ds_read_b128 v[56:59], v162 offset:24576
    ds_read_b128 v[60:63], v162 offset:25600
    ds_read_b128 v[64:67], v162 offset:26624
    ds_read_b128 v[68:71], v162 offset:27648
    s_waitcnt lgkmcnt(8)
    v_max3_f32 v6, v72, v74, v76
    v_max3_f32 v2, v78, v80, v82
    v_readfirstlane_b32 s79, v5
    v_max3_f32 v6, v6, v84, v86
    v_max_f32 v6, v6, v2
    s_cmp_lg_u32 s79, 7
    s_cbranch_scc1 L_end
    v_sub_f32 v72, v72, v6
    v_sub_f32 v74, v74, v6
    v_sub_f32 v76, v76, v6
    v_sub_f32 v78, v78, v6
    v_sub_f32 v80, v80, v6
    v_sub_f32 v82, v82, v6
    v_sub_f32 v84, v84, v6
    v_sub_f32 v86, v86, v6
    v_exp_f32 v72, v72
    v_exp_f32 v74, v74
    v_exp_f32 v76, v76
    v_exp_f32 v78, v78
    v_exp_f32 v80, v80
    v_exp_f32 v82, v82
    v_exp_f32 v84, v84
    v_exp_f32 v86, v86
    v_mul_f32 v7, v72, v73
    v_mul_f32 v2, v74, v75
    v_fmac_f32 v7, v76, v77
    v_fmac_f32 v2, v78, v79
    v_fmac_f32 v7, v80, v81
    v_fmac_f32 v2, v82, v83
    v_fmac_f32 v7, v84, v85
    v_fmac_f32 v2, v86, v87
    v_add_f32 v7, v7, v2
    v_rcp_f32 v2, v7
    v_log_f32 v7, v7
    s_nop 0
    v_add_f32 v7, v6, v7
    v_xor_b32 v6, s74, v7
    s_waitcnt lgkmcnt(0)
    v_pk_mul_f32 v[40:41], v[40:41], v[72:73] op_sel_hi:[1,0]
    v_pk_mul_f32 v[56:57], v[56:57], v[80:81] op_sel_hi:[1,0]
    v_pk_mul_f32 v[42:43], v[42:43], v[72:73] op_sel_hi:[1,0]
    v_pk_mul_f32 v[58:59], v[58:59], v[80:81] op_sel_hi:[1,0]
    v_pk_fma_f32 v[40:41], v[44:45], v[74:75], v[40:41] op_sel_hi:[1,0,1]
    v_pk_fma_f32 v[42:43], v[46:47], v[74:75], v[42:43] op_sel_hi:[1,0,1]
    v_pk_fma_f32 v[56:57], v[60:61], v[82:83], v[56:57] op_sel_hi:[1,0,1]
    v_pk_fma_f32 v[58:59], v[62:63], v[82:83], v[58:59] op_sel_hi:[1,0,1]
    v_pk_fma_f32 v[40:41], v[48:49], v[76:77], v[40:41] op_sel_hi:[1,0,1]
    v_pk_fma_f32 v[42:43], v[50:51], v[76:77], v[42:43] op_sel_hi:[1,0,1]
    v_pk_fma_f32 v[56:57], v[64:65], v[84:85], v[56:57] op_sel_hi:[1,0,1]
    v_pk_fma_f32 v[58:59], v[66:67], v[84:85], v[58:59] op_sel_hi:[1,0,1]
    v_pk_fma_f32 v[40:41], v[52:53], v[78:79], v[40:41] op_sel_hi:[1,0,1]
    v_pk_fma_f32 v[42:43], v[54:55], v[78:79], v[42:43] op_sel_hi:[1,0,1]
    v_pk_fma_f32 v[56:57], v[68:69], v[86:87], v[56:57] op_sel_hi:[1,0,1]
    v_pk_fma_f32 v[58:59], v[70:71], v[86:87], v[58:59] op_sel_hi:[1,0,1]
    v_pk_add_f32 v[42:43], v[42:43], v[58:59]
    v_pk_add_f32 v[40:41], v[40:41], v[56:57]
    v_pk_mul_f32 v[42:43], v[42:43], v[2:3] op_sel_hi:[1,0]
    v_pk_mul_f32 v[40:41], v[40:41], v[2:3] op_sel_hi:[1,0]
    v_perm_b32 v42, v43, v42, s55
    v_perm_b32 v40, v43, v40, s53
    v_perm_b32 v41, v43, v41, s54
    v_bitop3_b32 v4, v40, v41, v42 bitop3:0x96
    v_xor_b32 v6, v6, v4
    s_nop 0
    v_xor_b32_dpp v6, v4, v6 quad_perm:[1,0,3,2] row_mask:0xf bank_mask:0xf
    v_cndmask_b32 v43, v7, v6, s[56:57]
    buffer_store_dwordx4 v[40:43], v162, s[48:51], s75 offen sc1
    s_endpgm
L_rs0:
    v_max_f32 v3, 0, v2
    v_mov_b32 v4, v3
    s_nop 1
    v_permlane16_swap_b32 v4, v3
    v_max_f32 v3, v4, v3
    v_mov_b32 v4, v3
    s_nop 1
    v_permlane32_swap_b32 v4, v3
    v_max_f32 v3, v4, v3
    v_add_f32 v6, v6, v3
    v_sub_f32 v2, v2, v3
    v_sub_f32 v3, 0, v3
    v_exp_f32 v3, v3
    s_nop 0
    v_mul_f32 v16, v16, v3
    v_mul_f32 v17, v17, v3
    v_mul_f32 v18, v18, v3
    v_mul_f32 v19, v19, v3
    v_mul_f32 v20, v20, v3
    v_mul_f32 v21, v21, v3
    v_mul_f32 v22, v22, v3
    v_mul_f32 v23, v23, v3
    v_mul_f32 v148, v148, v3
    s_branch L_rb0
L_rs1:
    v_max_f32 v3, 0, v2
    v_mov_b32 v4, v3
    s_nop 1
    v_permlane16_swap_b32 v4, v3
    v_max_f32 v3, v4, v3
    v_mov_b32 v4, v3
    s_nop 1
    v_permlane32_swap_b32 v4, v3
    v_max_f32 v3, v4, v3
    v_add_f32 v6, v6, v3
    v_sub_f32 v2, v2, v3
    v_sub_f32 v3, 0, v3
    v_exp_f32 v3, v3
    s_nop 0
    v_mul_f32 v16, v16, v3
    v_mul_f32 v17, v17, v3
    v_mul_f32 v18, v18, v3
    v_mul_f32 v19, v19, v3
    v_mul_f32 v20, v20, v3
    v_mul_f32 v21, v21, v3
    v_mul_f32 v22, v22, v3
    v_mul_f32 v23, v23, v3
    v_mul_f32 v148, v148, v3
    s_branch L_rb1
L_trp:
    v_mov_b32 v152, -1
    s_sub_u32 s83, s83, 1
    s_cbranch_scc1 L_tgp
    s_sleep 8
    global_atomic_add_x2 v[152:153], v158, v[156:157], s[30:31] sc0 sc1
    s_waitcnt vmcnt(0)
    s_branch L_tkp
L_spp:
    s_sub_u32 s83, s83, 1
    s_cbranch_scc1 L_sgp
    s_sleep 1
    ds_read_b32 v4, v3 offset:28672
    s_branch L_swp
L_trd0:
    v_mov_b32 v152, -1
    s_sub_u32 s83, s83, 1
    s_cbranch_scc1 L_tgd0
    s_sleep 8
    global_atomic_add_x2 v[152:153], v158, v[156:157], s[30:31] sc0 sc1
    s_waitcnt vmcnt(0)
    s_branch L_tkd0
L_spd0:
    s_sub_u32 s83, s83, 1
    s_cbranch_scc1 L_sgd0
    s_sleep 1
    ds_read_b32 v4, v3 offset:28672
    s_branch L_swd0
L_trd1:
    v_mov_b32 v152, -1
    s_sub_u32 s83, s83, 1
    s_cbranch_scc1 L_tgd1
    s_sleep 8
    global_atomic_add_x2 v[152:153], v158, v[156:157], s[30:31] sc0 sc1
    s_waitcnt vmcnt(0)
    s_branch L_tkd1
L_spd1:
    s_sub_u32 s83, s83, 1
    s_cbranch_scc1 L_sgd1
    s_sleep 1
    ds_read_b32 v4, v3 offset:28672
    s_branch L_swd1
L_helper:
    s_setprio 3
    v_mov_b32 v4, 0
    v_mov_b32 v5, 0
    v_mov_b32 v6, 0
    v_mov_b32 v7, 0
    v_lshlrev_b32 v1, 4, v0
    v_and_b32 v3, 48, v1
    ds_write_b128 v3, v[4:7] offset:3840
    v_lshlrev_b32 v10, 3, v0
    ds_write_b64 v10, v[4:5] offset:28672
    v_lshrrev_b32 v8, 2, v0
    s_lshl_b32 s76, s3, 4
    v_add_u32 v8, s76, v8
    v_lshlrev_b32 v9, 2, v8
    v_lshl_or_b32 v8, v8, 14, v3
    s_lshr_b32 s76, s2, 4
    s_lshl_b32 s76, s76, 9
    s_and_b32 s77, s2, 3
    s_lshl_b32 s77, s77, 7
    s_add_u32 s76, s76, s77
    s_bfe_u32 s77, s2, 0x10003
    s_lshl_b32 s77, s77, 6
    s_add_u32 s76, s76, s77
    s_mov_b32 s53, 8192
    s_mov_b32 s54, 1048576
    s_mov_b32 s55, 1056768
    s_mov_b32 s56, 2097152
    s_mov_b32 s57, 2105344
    s_mov_b32 s58, 3145728
    s_mov_b32 s59, 3153920
    s_sub_u32 s34, 3670016, s76
    s_mov_b32 s35, 0x20000
    s_mov_b32 s38, 896
    s_mov_b32 s39, 0x20000
    s_mov_b32 s50, 0x800000
    s_mov_b32 s51, 0x20000
    s_bitcmp1_b32 s2, 2
    s_waitcnt lgkmcnt(0)
    s_cselect_b32 s32, s20, s10
    s_cselect_b32 s33, s21, s11
    s_cselect_b32 s77, 0x2000, 0
    s_add_u32 s32, s32, s76
    s_addc_u32 s33, s33, 0
    s_mov_b32 s36, s4
    s_mov_b32 s37, s5
    buffer_load_dword v16, v9, s[36:39], 0 offen offset:0
    buffer_load_dword v17, v9, s[36:39], 0 offen offset:256
    buffer_load_dword v18, v9, s[36:39], 0 offen offset:512
    buffer_load_dword v19, v9, s[36:39], 0 offen offset:768
    v_add_u32 v11, 3145728, v8
    buffer_load_dwordx4 v[104:107], v8, s[32:35], 0 offen nt
    buffer_load_dwordx4 v[108:111], v8, s[32:35], s53 offen nt
    buffer_load_dwordx4 v[112:115], v8, s[32:35], s54 offen nt
    buffer_load_dwordx4 v[116:119], v8, s[32:35], s55 offen nt
    buffer_load_dwordx4 v[120:123], v8, s[32:35], s56 offen nt
    buffer_load_dwordx4 v[124:127], v8, s[32:35], s57 offen nt
    buffer_load_dwordx4 v[128:131], v11, s[32:35], 0 offen nt
    buffer_load_dwordx4 v[132:135], v11, s[32:35], s53 offen nt
    s_load_dword s70, s[30:31], 0x8000
    s_barrier
    s_add_u32 s75, s76, s77
    s_lshl_b32 s75, s75, 1
    s_mov_b32 s48, s30
    s_mov_b32 s49, s31
    s_lshl_b32 s74, s2, 12
    s_mov_b32 s76, 0x05040100
    s_mov_b32 s77, 0x07060302
    v_lshrrev_b32 v4, 4, v0
    s_lshl_b32 s78, s3, 2
    v_add_u32 v4, s78, v4
    v_lshlrev_b32 v4, 7, v4
    v_lshl_or_b32 v4, v3, 1, v4
    v_and_b32 v5, 31, v0
    v_lshlrev_b32 v5, 2, v5
    v_lshrrev_b32 v6, 5, v0
    v_lshl_or_b32 v5, v6, 10, v5
    v_add_u32 v5, 1536, v5
    v_mov_b32 v6, 0
    v_mov_b32 v7, 1
    v_lshlrev_b32 v2, 2, v0
    s_lshr_b32 s72, s92, 5
    s_lshl_b32 s72, s72, 11
    s_add_u32 s72, s72, 0x4000
    s_lshr_b32 s73, s93, 4
    s_lshl_b32 s73, s73, 10
    v_lshlrev_b32 v10, 3, v0
    s_setprio 3
    s_waitcnt vmcnt(0) lgkmcnt(0)
    v_perm_b32 v28, v108, v104, s76
    v_perm_b32 v29, v108, v104, s77
    v_perm_b32 v30, v109, v105, s76
    v_perm_b32 v31, v109, v105, s77
    v_perm_b32 v32, v110, v106, s76
    v_perm_b32 v33, v110, v106, s77
    v_perm_b32 v34, v111, v107, s76
    v_perm_b32 v35, v111, v107, s77
    v_dot2_f32_bf16 v20, v28, v16, 0
    v_dot2_f32_bf16 v21, v29, v16, 0
    v_dot2_f32_bf16 v22, v30, v16, 0
    v_dot2_f32_bf16 v23, v31, v16, 0
    v_dot2_f32_bf16 v24, v32, v16, 0
    v_dot2_f32_bf16 v25, v33, v16, 0
    v_dot2_f32_bf16 v26, v34, v16, 0
    v_dot2_f32_bf16 v27, v35, v16, 0
    v_perm_b32 v28, v116, v112, s76
    v_perm_b32 v29, v116, v112, s77
    v_perm_b32 v30, v117, v113, s76
    v_perm_b32 v31, v117, v113, s77
    v_perm_b32 v32, v118, v114, s76
    v_perm_b32 v33, v118, v114, s77
    v_perm_b32 v34, v119, v115, s76
    v_perm_b32 v35, v119, v115, s77
    v_dot2_f32_bf16 v20, v28, v17, v20
    v_dot2_f32_bf16 v21, v29, v17, v21
    v_dot2_f32_bf16 v22, v30, v17, v22
    v_dot2_f32_bf16 v23, v31, v17, v23
    v_dot2_f32_bf16 v24, v32, v17, v24
    v_dot2_f32_bf16 v25, v33, v17, v25
    v_dot2_f32_bf16 v26, v34, v17, v26
    v_dot2_f32_bf16 v27, v35, v17, v27
    v_perm_b32 v28, v124, v120, s76
    v_perm_b32 v29, v124, v120, s77
    v_perm_b32 v30, v125, v121, s76
    v_perm_b32 v31, v125, v121, s77
    v_perm_b32 v32, v126, v122, s76
    v_perm_b32 v33, v126, v122, s77
    v_perm_b32 v34, v127, v123, s76
    v_perm_b32 v35, v127, v123, s77
    v_dot2_f32_bf16 v20, v28, v18, v20
    v_dot2_f32_bf16 v21, v29, v18, v21
    v_dot2_f32_bf16 v22, v30, v18, v22
    v_dot2_f32_bf16 v23, v31, v18, v23
    v_dot2_f32_bf16 v24, v32, v18, v24
    v_dot2_f32_bf16 v25, v33, v18, v25
    v_dot2_f32_bf16 v26, v34, v18, v26
    v_dot2_f32_bf16 v27, v35, v18, v27
    v_perm_b32 v28, v132, v128, s76
    v_perm_b32 v29, v132, v128, s77
    v_perm_b32 v30, v133, v129, s76
    v_perm_b32 v31, v133, v129, s77
    v_perm_b32 v32, v134, v130, s76
    v_perm_b32 v33, v134, v130, s77
    v_perm_b32 v34, v135, v131, s76
    v_perm_b32 v35, v135, v131, s77
    v_dot2_f32_bf16 v20, v28, v19, v20
    v_dot2_f32_bf16 v21, v29, v19, v21
    v_dot2_f32_bf16 v22, v30, v19, v22
    v_dot2_f32_bf16 v23, v31, v19, v23
    v_dot2_f32_bf16 v24, v32, v19, v24
    v_dot2_f32_bf16 v25, v33, v19, v25
    v_dot2_f32_bf16 v26, v34, v19, v26
    v_dot2_f32_bf16 v27, v35, v19, v27
    v_add_f32_dpp v20, v20, v20 row_ror:4 row_mask:0xf bank_mask:0xf
    v_add_f32_dpp v21, v21, v21 row_ror:4 row_mask:0xf bank_mask:0xf
    v_add_f32_dpp v22, v22, v22 row_ror:4 row_mask:0xf bank_mask:0xf
    v_add_f32_dpp v23, v23, v23 row_ror:4 row_mask:0xf bank_mask:0xf
    v_add_f32_dpp v24, v24, v24 row_ror:4 row_mask:0xf bank_mask:0xf
    v_add_f32_dpp v25, v25, v25 row_ror:4 row_mask:0xf bank_mask:0xf
    v_add_f32_dpp v26, v26, v26 row_ror:4 row_mask:0xf bank_mask:0xf
    v_add_f32_dpp v27, v27, v27 row_ror:4 row_mask:0xf bank_mask:0xf
    v_add_f32_dpp v20, v20, v20 row_ror:8 row_mask:0xf bank_mask:0xf
    v_add_f32_dpp v21, v21, v21 row_ror:8 row_mask:0xf bank_mask:0xf
    v_add_f32_dpp v22, v22, v22 row_ror:8 row_mask:0xf bank_mask:0xf
    v_add_f32_dpp v23, v23, v23 row_ror:8 row_mask:0xf bank_mask:0xf
    v_add_f32_dpp v24, v24, v24 row_ror:8 row_mask:0xf bank_mask:0xf
    v_add_f32_dpp v25, v25, v25 row_ror:8 row_mask:0xf bank_mask:0xf
    v_add_f32_dpp v26, v26, v26 row_ror:8 row_mask:0xf bank_mask:0xf
    v_add_f32_dpp v27, v27, v27 row_ror:8 row_mask:0xf bank_mask:0xf
    s_mov_b32 exec_lo, 0x000f000f
    s_mov_b32 exec_hi, 0x000f000f
    ds_write_b128 v4, v[20:23] offset:1536
    ds_write_b128 v4, v[24:27] offset:1552
    s_mov_b64 exec, 1
    ds_add_rtn_u32 v9, v6, v7 offset:3840
    s_mov_b64 exec, -1
    ds_read2_b32 v[28:29], v5 offset0:0 offset1:32
    ds_read2_b32 v[30:31], v5 offset0:64 offset1:96
    ds_read2_b32 v[32:33], v5 offset0:128 offset1:160
    ds_read2_b32 v[34:35], v5 offset0:192 offset1:224
    s_waitcnt lgkmcnt(0)
    v_readfirstlane_b32 s71, v9
    s_mul_i32 s70, s70, 0x9e3779b1
    s_add_u32 s70, s70, 0x7f4a7c15
    s_cmp_lg_u32 s71, 3
    s_cbranch_scc1 L_h_wq
    v_add_f32 v28, v28, v29
    v_add_f32 v30, v30, v31
    v_add_f32 v32, v32, v33
    v_add_f32 v34, v34, v35
    v_add_f32 v28, v28, v30
    v_add_f32 v32, v32, v34
    v_add_f32 v28, v28, v32
    v_mov_b32 v29, v28
    s_nop 1
    v_permlane32_swap_b32 v29, v28
    v_add_f32 v28, v28, v29
    s_nop 1
    v_mov_b32_dpp v29, v28 quad_perm:[1,0,3,2] row_mask:0xf bank_mask:0xf
    s_getreg_b32 s79, hwreg(HW_REG_XCC_ID, 0, 4)
    s_xor_b32 s79, s79, s70
    v_cvt_pk_bf16_f32 v28, v28, v29
    v_mov_b32 v29, s79
    s_mov_b32 exec_lo, 0x55555555
    s_mov_b32 exec_hi, 0
    buffer_store_dwordx2 v[28:29], v2, s[48:51], s75 offen sc1
    s_mov_b64 exec, 0xffff
    v_mov_b32 v30, 0
    v_mov_b32 v31, s70
    ds_write_b32 v6, v31 offset:3884
    s_cmp_ge_u32 s2, 16
    s_cbranch_scc1 L_h_noci
    s_mul_i32 s76, s2, 4352
    s_add_u32 s76, s76, 65536
    buffer_store_dwordx2 v[30:31], v10, s[48:51], s76 offen sc1
L_h_noci:
    s_mov_b64 exec, -1
    s_mov_b32 s83, 3200000
L_prg_w:
    ds_read_b32 v4, v6 offset:3880
    s_waitcnt lgkmcnt(0)
    v_readfirstlane_b32 s76, v4
    s_sub_u32 s83, s83, 1
    s_cbranch_scc1 L_prg_g
    s_cmp_ge_u32 s76, 4
    s_cbranch_scc1 L_prg_g
    s_sleep 2
    s_branch L_prg_w
L_prg_g:
    s_mov_b32 s83, 400000
L_h_fw:
    buffer_load_dwordx4 v[16:19], v1, s[48:51], s72 offen sc1
    buffer_load_dwordx4 v[20:23], v1, s[48:51], s72 offen offset:1024 sc1
    buffer_load_dwordx4 v[24:27], v1, s[48:51], s73 offen sc1
    s_waitcnt vmcnt(0)
    v_xor_b32 v4, s79, v17
    v_xor_b32 v5, s79, v19
    v_xor_b32 v8, s79, v21
    v_xor_b32 v9, s79, v23
    v_xor_b32 v11, s79, v25
    v_xor_b32 v12, s79, v27
    v_or3_b32 v4, v4, v5, v8
    v_or_b32 v4, v4, v9
    v_or3_b32 v9, v4, v11, v12
    v_cmp_lt_u32 vcc, 15, v9
    s_sub_u32 s83, s83, 1
    s_cbranch_scc1 L_h_fg
    s_cbranch_vccnz L_h_fw
L_h_fg:
    ds_write2_b32 v10, v16, v18 offset0:0 offset1:1
    ds_write2_b32 v10, v20, v22 offset0:128 offset1:129
    v_add_u32 v10, 1024, v10
    ds_write2_b32 v10, v24, v26 offset0:0 offset1:1
    v_cmp_ne_u32 vcc, 0, v4
    s_nop 0
    s_cmp_lg_u64 vcc, 0
    s_cselect_b32 s76, 1, 12
    v_mov_b32 v5, s76
    s_mov_b64 exec, 1
    ds_write_b32 v6, v5 offset:3844
    s_mov_b64 exec, -1
L_h_wq:
    s_mov_b32 s83, 3200000
L_bq_w:
    ds_read_b32 v4, v6 offset:3844
    s_waitcnt lgkmcnt(0)
    v_readfirstlane_b32 s76, v4
    s_sub_u32 s83, s83, 1
    s_cbranch_scc1 L_bq_g
    s_cmp_lg_u32 s76, 0
    s_cbranch_scc1 L_bq_g
    s_sleep 4
    s_branch L_bq_w
L_bq_g:
    s_max_u32 s94, s76, 1
    v_lshrrev_b32 v4, 4, v0
    v_and_b32 v5, 8, v0
    v_lshl_add_u32 v12, v5, 1, v4
    v_mul_u32_u24 v12, 896, v12
    v_and_b32 v16, 0x70, v1
    v_add_u32 v12, v12, v16
    v_add_u32 v13, 3584, v12
    v_add_u32 v14, 7168, v12
    v_add_u32 v15, 10752, v12
    s_and_b32 s76, s2, 31
    s_lshl2_add_u32 s73, s76, s71
    s_mul_i32 s76, s73, 28672
    s_lshr_b32 s78, s2, 5
    s_min_u32 s78, s78, 6
    s_lshl_b32 s78, s78, 7
    s_add_u32 s76, s76, s78
    s_sub_u32 s34, 28672, s78
    s_mov_b32 s46, s34
    s_mov_b32 s47, 0x20000
    s_add_u32 s32, s22, s76
    s_addc_u32 s33, s23, 0
    s_add_u32 s44, s12, s76
    s_addc_u32 s45, s13, 0
    v_lshrrev_b32 v17, 3, v0
    v_mul_u32_u24 v70, 1152, v17
    v_add_u32 v70, v70, v16
    v_lshrrev_b32 v17, 1, v0
    v_mul_u32_u24 v64, 640, v17
    v_and_b32 v17, 1, v0
    v_lshl_add_u32 v64, v17, 8, v64
    v_lshrrev_b32 v17, 5, v0
    v_lshlrev_b32 v17, 8, v17
    v_lshl_or_b32 v17, v16, 1, v17
    v_and_b32 v18, 16, v0
    s_lshl_b32 s76, s71, 9
    v_or3_b32 v65, v17, v18, s76
    v_and_b32 v17, 15, v0
    v_lshlrev_b32 v4, 1, v4
    v_lshl_or_b32 v62, v17, 20, v4
    v_and_b32 v4, 1, v0
    v_lshlrev_b32 v4, 4, v4
    v_mov_b32 v5, 0xffff
    v_lshlrev_b32 v4, v4, v5
    v_bfe_u32 v5, v0, 1, 2
    v_cmp_eq_u32 vcc, 0, v5
    s_nop 1
    v_cndmask_b32 v8, 0, v4, vcc
    v_cmp_eq_u32 vcc, 1, v5
    s_nop 1
    v_cndmask_b32 v9, 0, v4, vcc
    v_cmp_eq_u32 vcc, 2, v5
    s_nop 1
    v_cndmask_b32 v10, 0, v4, vcc
    v_cmp_eq_u32 vcc, 3, v5
    s_nop 1
    v_cndmask_b32 v11, 0, v4, vcc
    s_mov_b32 s63, 0x0c04000c
    s_lshr_b32 s76, s73, 3
    s_mul_i32 s76, s76, 18432
    s_and_b32 s77, s73, 7
    s_lshl_b32 s77, s77, 7
    s_add_u32 s62, s76, s77
    s_add_u32 s62, s62, 4194304
    s_add_u32 s72, s62, 9216
    s_lshl_b32 s73, s73, 7
    s_add_u32 s73, s73, 3670016
    s_mul_i32 s68, s2, 640
    s_add_u32 s68, s68, 1048576
    s_add_u32 s56, s30, s68
    s_addc_u32 s57, s31, 0
    s_mov_b32 s58, 0
    s_mov_b32 s59, 0x20000
    s_and_b32 s76, s2, 0xe0
    s_mul_i32 s60, s76, 640
    s_bfe_u32 s77, s2, 0x40001
    s_lshl4_add_u32 s60, s77, s60
    s_add_u32 s60, s60, 1048576
    s_lshl3_add_u32 s77, s77, s78
    s_add_u32 s64, s26, s77
    s_addc_u32 s65, s27, 0
    s_mov_b32 s66, 0
    s_mov_b32 s67, 0x20000
    s_mov_b32 s80, 0x03020105
    s_mov_b32 s81, 0x03020106
    s_mov_b32 s82, 0x03020107
    s_cmp_lg_u32 s71, 2
    s_cbranch_scc1 L_b_rd
    s_mov_b32 s52, s24
    s_mov_b32 s53, s25
    s_mov_b32 s54, 896
    s_mov_b32 s55, 0x20000
    buffer_load_dwordx4 v[16:19], v1, s[36:39], 0 offen
    buffer_load_dwordx4 v[20:23], v1, s[52:55], 0 offen
    s_waitcnt vmcnt(0)
    v_lshlrev_b32 v24, 16, v16
    v_and_b32 v25, 0xffff0000, v16
    v_lshlrev_b32 v26, 16, v20
    v_and_b32 v27, 0xffff0000, v20
    v_mul_f32 v24, v24, v26
    v_mul_f32 v25, v25, v27
    v_cvt_pk_bf16_f32 v24, v24, v25
    v_lshlrev_b32 v25, 16, v24
    v_and_b32 v24, 0xffff0000, v24
    v_add_f32 v28, v24, v25
    v_lshlrev_b32 v24, 16, v17
    v_and_b32 v25, 0xffff0000, v17
    v_lshlrev_b32 v26, 16, v21
    v_and_b32 v27, 0xffff0000, v21
    v_mul_f32 v24, v24, v26
    v_mul_f32 v25, v25, v27
    v_cvt_pk_bf16_f32 v24, v24, v25
    v_lshlrev_b32 v25, 16, v24
    v_and_b32 v24, 0xffff0000, v24
    v_add_f32 v28, v28, v24
    v_add_f32 v28, v28, v25
    v_lshlrev_b32 v24, 16, v18
    v_and_b32 v25, 0xffff0000, v18
    v_lshlrev_b32 v26, 16, v22
    v_and_b32 v27, 0xffff0000, v22
    v_mul_f32 v24, v24, v26
    v_mul_f32 v25, v25, v27
    v_cvt_pk_bf16_f32 v24, v24, v25
    v_lshlrev_b32 v25, 16, v24
    v_and_b32 v24, 0xffff0000, v24
    v_add_f32 v28, v28, v24
    v_add_f32 v28, v28, v25
    v_lshlrev_b32 v24, 16, v19
    v_and_b32 v25, 0xffff0000, v19
    v_lshlrev_b32 v26, 16, v23
    v_and_b32 v27, 0xffff0000, v23
    v_mul_f32 v24, v24, v26
    v_mul_f32 v25, v25, v27
    v_cvt_pk_bf16_f32 v24, v24, v25
    v_lshlrev_b32 v25, 16, v24
    v_and_b32 v24, 0xffff0000, v24
    v_add_f32 v28, v28, v24
    v_add_f32 v28, v28, v25
    s_nop 1
    v_add_f32_dpp v28, v28, v28 quad_perm:[1,0,3,2] row_mask:0xf bank_mask:0xf
    s_nop 1
    v_add_f32_dpp v28, v28, v28 quad_perm:[2,3,0,1] row_mask:0xf bank_mask:0xf
    s_nop 1
    v_add_f32_dpp v28, v28, v28 row_half_mirror row_mask:0xf bank_mask:0xf
    s_nop 1
    v_add_f32_dpp v28, v28, v28 row_mirror row_mask:0xf bank_mask:0xf
    v_mov_b32 v29, v28
    s_nop 1
    v_permlane16_swap_b32 v29, v28
    v_add_f32 v28, v29, v28
    v_mov_b32 v29, v28
    s_nop 1
    v_permlane32_swap_b32 v29, v28
    v_add_f32 v28, v29, v28
    v_cvt_pk_bf16_f32 v28, v28, v28
    v_and_b32 v28, 0xffff0000, v28
    v_mul_f32 v28, 0xbfb8aa3b, v28
    v_exp_f32 v28, v28
    s_nop 0
    v_add_f32 v28, 1.0, v28
    v_rcp_f32 v28, v28
    s_nop 0
    v_cvt_pk_bf16_f32 v28, v28, v28
    v_and_b32 v61, 0xffff0000, v28
    v_sub_f32 v28, 1.0, v61
    v_cvt_pk_bf16_f32 v28, v28, v28
    v_and_b32 v60, 0xffff0000, v28
    ds_write_b32 v6, v61 offset:3892
    s_mov_b32 s83, 3200000
L_vb_w:
    ds_read_b32 v4, v6 offset:3856
    s_waitcnt lgkmcnt(0)
    v_readfirstlane_b32 s76, v4
    s_sub_u32 s83, s83, 1
    s_cbranch_scc1 L_vb_g
    s_cmp_eq_u32 s76, 8
    s_cbranch_scc1 L_vb_g
    s_sleep 4
    s_branch L_vb_w
L_vb_g:
    s_mul_i32 s76, s92, 1152
    s_add_u32 s76, s76, 2097152
    s_mov_b32 s55, s76
    s_getreg_b32 s79, hwreg(HW_REG_XCC_ID, 0, 4)
    s_add_u32 s79, s79, s70
    s_add_u32 s79, s79, 1
    ds_read_b128 v[16:19], v6 offset:3584
    ds_read_b128 v[20:23], v6 offset:3600
    ds_read_b128 v[24:27], v6 offset:3712
    ds_read_b128 v[28:31], v6 offset:3728
    s_waitcnt lgkmcnt(0)
    v_max3_f32 v88, v16, v17, v18
    v_max3_f32 v88, v88, v19, v20
    v_max3_f32 v88, v88, v21, v22
    v_max_f32 v88, v88, v23
    v_sub_f32 v16, v16, v88
    v_sub_f32 v17, v17, v88
    v_sub_f32 v18, v18, v88
    v_sub_f32 v19, v19, v88
    v_sub_f32 v20, v20, v88
    v_sub_f32 v21, v21, v88
    v_sub_f32 v22, v22, v88
    v_sub_f32 v23, v23, v88
    v_exp_f32 v16, v16
    v_exp_f32 v17, v17
    v_exp_f32 v18, v18
    v_exp_f32 v19, v19
    v_exp_f32 v20, v20
    v_exp_f32 v21, v21
    v_exp_f32 v22, v22
    v_exp_f32 v23, v23
    v_mul_f32 v90, v16, v24
    v_fmac_f32 v90, v17, v25
    v_fmac_f32 v90, v18, v26
    v_fmac_f32 v90, v19, v27
    v_fmac_f32 v90, v20, v28
    v_fmac_f32 v90, v21, v29
    v_fmac_f32 v90, v22, v30
    v_fmac_f32 v90, v23, v31
    ds_read_b128 v[32:35], v1 offset:4096
    ds_read_b128 v[36:39], v1 offset:5120
    ds_read_b128 v[40:43], v1 offset:6144
    ds_read_b128 v[44:47], v1 offset:7168
    s_waitcnt lgkmcnt(0)
    v_mul_f32 v96, v32, v16
    v_mul_f32 v97, v33, v16
    v_mul_f32 v98, v34, v16
    v_mul_f32 v99, v35, v16
    v_fmac_f32 v96, v36, v17
    v_fmac_f32 v97, v37, v17
    v_fmac_f32 v98, v38, v17
    v_fmac_f32 v99, v39, v17
    v_fmac_f32 v96, v40, v18
    v_fmac_f32 v97, v41, v18
    v_fmac_f32 v98, v42, v18
    v_fmac_f32 v99, v43, v18
    v_fmac_f32 v96, v44, v19
    v_fmac_f32 v97, v45, v19
    v_fmac_f32 v98, v46, v19
    v_fmac_f32 v99, v47, v19
    ds_read_b128 v[32:35], v1 offset:8192
    ds_read_b128 v[36:39], v1 offset:9216
    ds_read_b128 v[40:43], v1 offset:10240
    ds_read_b128 v[44:47], v1 offset:11264
    s_waitcnt lgkmcnt(0)
    v_fmac_f32 v96, v32, v20
    v_fmac_f32 v97, v33, v20
    v_fmac_f32 v98, v34, v20
    v_fmac_f32 v99, v35, v20
    v_fmac_f32 v96, v36, v21
    v_fmac_f32 v97, v37, v21
    v_fmac_f32 v98, v38, v21
    v_fmac_f32 v99, v39, v21
    v_fmac_f32 v96, v40, v22
    v_fmac_f32 v97, v41, v22
    v_fmac_f32 v98, v42, v22
    v_fmac_f32 v99, v43, v22
    v_fmac_f32 v96, v44, v23
    v_fmac_f32 v97, v45, v23
    v_fmac_f32 v98, v46, v23
    v_fmac_f32 v99, v47, v23
    v_cvt_pk_bf16_f32 v96, v96, v97
    v_cvt_pk_bf16_f32 v97, v98, v99
    v_lshlrev_b32 v5, 3, v0
    buffer_store_dwordx2 v[96:97], v5, s[48:51], s76 offen offset:0
    ds_read_b128 v[16:19], v6 offset:3616
    ds_read_b128 v[20:23], v6 offset:3632
    ds_read_b128 v[24:27], v6 offset:3744
    ds_read_b128 v[28:31], v6 offset:3760
    s_waitcnt lgkmcnt(0)
    v_max3_f32 v92, v16, v17, v18
    v_max3_f32 v92, v92, v19, v20
    v_max3_f32 v92, v92, v21, v22
    v_max_f32 v92, v92, v23
    v_sub_f32 v16, v16, v92
    v_sub_f32 v17, v17, v92
    v_sub_f32 v18, v18, v92
    v_sub_f32 v19, v19, v92
    v_sub_f32 v20, v20, v92
    v_sub_f32 v21, v21, v92
    v_sub_f32 v22, v22, v92
    v_sub_f32 v23, v23, v92
    v_exp_f32 v16, v16
    v_exp_f32 v17, v17
    v_exp_f32 v18, v18
    v_exp_f32 v19, v19
    v_exp_f32 v20, v20
    v_exp_f32 v21, v21
    v_exp_f32 v22, v22
    v_exp_f32 v23, v23
    v_mul_f32 v94, v16, v24
    v_fmac_f32 v94, v17, v25
    v_fmac_f32 v94, v18, v26
    v_fmac_f32 v94, v19, v27
    v_fmac_f32 v94, v20, v28
    v_fmac_f32 v94, v21, v29
    v_fmac_f32 v94, v22, v30
    v_fmac_f32 v94, v23, v31
    ds_read_b128 v[32:35], v1 offset:12288
    ds_read_b128 v[36:39], v1 offset:13312
    ds_read_b128 v[40:43], v1 offset:14336
    ds_read_b128 v[44:47], v1 offset:15360
    s_waitcnt lgkmcnt(0)
    v_mul_f32 v100, v32, v16
    v_mul_f32 v101, v33, v16
    v_mul_f32 v102, v34, v16
    v_mul_f32 v103, v35, v16
    v_fmac_f32 v100, v36, v17
    v_fmac_f32 v101, v37, v17
    v_fmac_f32 v102, v38, v17
    v_fmac_f32 v103, v39, v17
    v_fmac_f32 v100, v40, v18
    v_fmac_f32 v101, v41, v18
    v_fmac_f32 v102, v42, v18
    v_fmac_f32 v103, v43, v18
    v_fmac_f32 v100, v44, v19
    v_fmac_f32 v101, v45, v19
    v_fmac_f32 v102, v46, v19
    v_fmac_f32 v103, v47, v19
    ds_read_b128 v[32:35], v1 offset:16384
    ds_read_b128 v[36:39], v1 offset:17408
    ds_read_b128 v[40:43], v1 offset:18432
    ds_read_b128 v[44:47], v1 offset:19456
    s_waitcnt lgkmcnt(0)
    v_fmac_f32 v100, v32, v20
    v_fmac_f32 v101, v33, v20
    v_fmac_f32 v102, v34, v20
    v_fmac_f32 v103, v35, v20
    v_fmac_f32 v100, v36, v21
    v_fmac_f32 v101, v37, v21
    v_fmac_f32 v102, v38, v21
    v_fmac_f32 v103, v39, v21
    v_fmac_f32 v100, v40, v22
    v_fmac_f32 v101, v41, v22
    v_fmac_f32 v102, v42, v22
    v_fmac_f32 v103, v43, v22
    v_fmac_f32 v100, v44, v23
    v_fmac_f32 v101, v45, v23
    v_fmac_f32 v102, v46, v23
    v_fmac_f32 v103, v47, v23
    v_cvt_pk_bf16_f32 v100, v100, v101
    v_cvt_pk_bf16_f32 v101, v102, v103
    v_lshlrev_b32 v5, 3, v0
    buffer_store_dwordx2 v[100:101], v5, s[48:51], s76 offen offset:512
    v_and_b32 v4, 1, v0
    v_cmp_eq_u32 vcc, 1, v4
    s_nop 1
    v_cndmask_b32 v88, v88, v92, vcc
    v_cndmask_b32 v90, v90, v94, vcc
    v_mov_b32 v89, s79
    v_mov_b32 v91, s79
    s_waitcnt vmcnt(0)
    s_mov_b64 exec, 0xff
    buffer_store_dwordx4 v[88:91], v1, s[48:51], s76 offen offset:1024
    s_mov_b64 exec, -1
    v_and_b32 v4, 31, v0
    v_mul_u32_u24 v69, 1152, v4
    v_lshrrev_b32 v5, 3, v0
    v_mul_u32_u24 v68, 1152, v5
    v_and_b32 v16, 7, v0
    v_lshl_add_u32 v68, v16, 4, v68
    v_lshlrev_b32 v66, 4, v5
    v_lshrrev_b32 v4, 3, v4
    v_lshl_or_b32 v67, v16, 2, v4
    v_lshlrev_b32 v67, 2, v67
    v_lshrrev_b32 v5, 4, v0
    v_lshlrev_b32 v5, 3, v5
    v_lshl_or_b32 v71, v16, 5, v5
    s_and_b32 s76, s2, 0xe0
    s_mul_i32 s76, s76, 1152
    s_add_u32 s76, s76, 2097152
    s_bfe_u32 s77, s2, 0x10004
    s_lshl4_add_u32 s54, s77, s76
    s_add_u32 s54, s54, 1024
    s_and_b32 s77, s2, 28
    s_lshl_b32 s77, s77, 5
    s_add_u32 s52, s76, s77
    s_mov_b32 s83, 3200000
L_kb_w:
    ds_read_b32 v4, v6 offset:3852
    s_waitcnt lgkmcnt(0)
    v_readfirstlane_b32 s76, v4
    s_sub_u32 s83, s83, 1
    s_cbranch_scc1 L_kb_g
    s_cmp_ge_u32 s76, 1
    s_cbranch_scc1 L_kb_g
    s_sleep 8
    s_branch L_kb_w
L_kb_g:
    s_mov_b32 s83, 400000
    s_mov_b32 s53, s94
    s_mov_b32 s69, 1
L_b_w:
    buffer_load_dwordx4 v[24:27], v69, s[48:51], s54 offen sc1
    s_waitcnt vmcnt(0)
    v_xor_b32 v4, s79, v25
    v_xor_b32 v5, s79, v27
    v_or_b32 v4, v4, v5
    v_cmp_ne_u32 vcc, 0, v4
    s_cbranch_vccz L_b_g
    v_xor_b32 v16, s70, v25
    v_xor_b32 v5, s70, v27
    v_or_b32 v16, v16, v5
    v_cmp_eq_u32 s[76:77], 0, v16
    s_nop 0
    s_cmp_lg_u64 s[76:77], 0
    s_cselect_b32 s78, 1, s53
    s_min_u32 s53, s53, s78
    s_andn2_b64 s[76:77], vcc, s[76:77]
    s_cmp_eq_u32 s53, 0
    s_cbranch_scc1 L_b_n
    s_sub_u32 s53, s53, 1
    s_cmp_lg_u32 s53, 0
    s_cbranch_scc1 L_b_n
    v_lshlrev_b32 v5, 3, v0
    v_mov_b32 v89, s70
    v_mov_b32 v91, s70
    buffer_store_dwordx2 v[96:97], v5, s[48:51], s55 offen sc1
    buffer_store_dwordx2 v[100:101], v5, s[48:51], s55 offen offset:512 sc1
    s_waitcnt vmcnt(0)
    s_mov_b64 exec, 0xff
    buffer_store_dwordx4 v[88:91], v1, s[48:51], s55 offen offset:1024 sc1
    s_mov_b64 exec, -1
L_b_n:
    s_mov_b32 s69, 2
    s_cmp_eq_u64 s[76:77], 0
    s_cbranch_scc1 L_b_g
    s_sub_u32 s83, s83, 1
    s_cbranch_scc1 L_b_g
    s_mov_b32 s69, 1
    s_sleep 32
    s_branch L_b_w
L_b_g:
    s_and_b32 s76, s2, 3
    s_cbranch_scc1 L_b_f
    buffer_load_dwordx4 v[28:31], v68, s[48:51], s52 offen sc1
    s_add_u32 s52, s52, 9216
    buffer_load_dwordx4 v[32:35], v68, s[48:51], s52 offen sc1
    s_add_u32 s52, s52, 9216
    buffer_load_dwordx4 v[36:39], v68, s[48:51], s52 offen sc1
    s_add_u32 s52, s52, 9216
    buffer_load_dwordx4 v[40:43], v68, s[48:51], s52 offen sc1
    s_add_u32 s52, s52, 9216
    v_mov_b32 v4, v24
    s_nop 1
    v_max_f32_dpp v4, v4, v4 quad_perm:[1,0,3,2] row_mask:0xf bank_mask:0xf
    s_nop 1
    v_max_f32_dpp v4, v4, v4 quad_perm:[2,3,0,1] row_mask:0xf bank_mask:0xf
    s_nop 1
    v_max_f32_dpp v4, v4, v4 row_half_mirror row_mask:0xf bank_mask:0xf
    s_nop 1
    v_max_f32_dpp v4, v4, v4 row_mirror row_mask:0xf bank_mask:0xf
    v_mov_b32 v5, v4
    s_nop 1
    v_permlane16_swap_b32 v5, v4
    v_max_f32 v4, v5, v4
    v_mov_b32 v5, v4
    s_nop 1
    v_permlane32_swap_b32 v5, v4
    v_max_f32 v4, v5, v4
    v_sub_f32 v24, v24, v4
    v_exp_f32 v24, v24
    s_nop 0
    v_mul_f32 v26, v26, v24
    s_nop 1
    v_add_f32_dpp v26, v26, v26 quad_perm:[1,0,3,2] row_mask:0xf bank_mask:0xf
    s_nop 1
    v_add_f32_dpp v26, v26, v26 quad_perm:[2,3,0,1] row_mask:0xf bank_mask:0xf
    s_nop 1
    v_add_f32_dpp v26, v26, v26 row_half_mirror row_mask:0xf bank_mask:0xf
    s_nop 1
    v_add_f32_dpp v26, v26, v26 row_mirror row_mask:0xf bank_mask:0xf
    v_mov_b32 v5, v26
    s_nop 1
    v_permlane16_swap_b32 v5, v26
    v_add_f32 v26, v26, v5
    v_rcp_f32 v26, v26
    v_mul_f32 v24, v24, v60
    v_mul_f32 v24, v24, v26
    ds_write_b32 v67, v24 offset:4096
    ds_read_b128 v[16:19], v66 offset:4096
    s_waitcnt vmcnt(0) lgkmcnt(0)
    v_lshlrev_b32 v20, 16, v28
    v_and_b32 v21, 0xffff0000, v28
    v_mul_f32 v44, v20, v16
    v_mul_f32 v45, v21, v16
    v_lshlrev_b32 v20, 16, v29
    v_and_b32 v21, 0xffff0000, v29
    v_mul_f32 v46, v20, v16
    v_mul_f32 v47, v21, v16
    v_lshlrev_b32 v20, 16, v30
    v_and_b32 v21, 0xffff0000, v30
    v_mul_f32 v48, v20, v16
    v_mul_f32 v49, v21, v16
    v_lshlrev_b32 v20, 16, v31
    v_and_b32 v21, 0xffff0000, v31
    v_mul_f32 v50, v20, v16
    v_mul_f32 v51, v21, v16
    v_lshlrev_b32 v20, 16, v32
    v_and_b32 v21, 0xffff0000, v32
    v_fmac_f32 v44, v20, v17
    v_fmac_f32 v45, v21, v17
    v_lshlrev_b32 v20, 16, v33
    v_and_b32 v21, 0xffff0000, v33
    v_fmac_f32 v46, v20, v17
    v_fmac_f32 v47, v21, v17
    v_lshlrev_b32 v20, 16, v34
    v_and_b32 v21, 0xffff0000, v34
    v_fmac_f32 v48, v20, v17
    v_fmac_f32 v49, v21, v17
    v_lshlrev_b32 v20, 16, v35
    v_and_b32 v21, 0xffff0000, v35
    v_fmac_f32 v50, v20, v17
    v_fmac_f32 v51, v21, v17
    v_lshlrev_b32 v20, 16, v36
    v_and_b32 v21, 0xffff0000, v36
    v_fmac_f32 v44, v20, v18
    v_fmac_f32 v45, v21, v18
    v_lshlrev_b32 v20, 16, v37
    v_and_b32 v21, 0xffff0000, v37
    v_fmac_f32 v46, v20, v18
    v_fmac_f32 v47, v21, v18
    v_lshlrev_b32 v20, 16, v38
    v_and_b32 v21, 0xffff0000, v38
    v_fmac_f32 v48, v20, v18
    v_fmac_f32 v49, v21, v18
    v_lshlrev_b32 v20, 16, v39
    v_and_b32 v21, 0xffff0000, v39
    v_fmac_f32 v50, v20, v18
    v_fmac_f32 v51, v21, v18
    v_lshlrev_b32 v20, 16, v40
    v_and_b32 v21, 0xffff0000, v40
    v_fmac_f32 v44, v20, v19
    v_fmac_f32 v45, v21, v19
    v_lshlrev_b32 v20, 16, v41
    v_and_b32 v21, 0xffff0000, v41
    v_fmac_f32 v46, v20, v19
    v_fmac_f32 v47, v21, v19
    v_lshlrev_b32 v20, 16, v42
    v_and_b32 v21, 0xffff0000, v42
    v_fmac_f32 v48, v20, v19
    v_fmac_f32 v49, v21, v19
    v_lshlrev_b32 v20, 16, v43
    v_and_b32 v21, 0xffff0000, v43
    v_fmac_f32 v50, v20, v19
    v_fmac_f32 v51, v21, v19
    v_permlane32_swap_b32 v44, v48
    v_permlane32_swap_b32 v45, v49
    v_permlane32_swap_b32 v46, v50
    v_permlane32_swap_b32 v47, v51
    v_add_f32 v44, v44, v48
    v_add_f32 v45, v45, v49
    v_add_f32 v46, v46, v50
    v_add_f32 v47, v47, v51
    s_nop 0
    v_permlane16_swap_b32 v44, v46
    v_permlane16_swap_b32 v45, v47
    v_add_f32 v44, v44, v46
    v_add_f32 v45, v45, v47
    s_nop 0
    v_add_f32_dpp v44, v44, v44 row_ror:8 row_mask:0xf bank_mask:0xf
    v_add_f32_dpp v45, v45, v45 row_ror:8 row_mask:0xf bank_mask:0xf
    ds_write_b64 v71, v[44:45] offset:5120
    s_mov_b64 exec, 0xffff
    ds_read_b128 v[16:19], v1 offset:5120
    s_lshl_b32 s76, s2, 6
    s_add_u32 s76, s76, 3670016
    s_waitcnt lgkmcnt(0)
    v_perm_b32 v16, v19, v16, s80
    v_perm_b32 v17, v19, v17, s81
    v_perm_b32 v18, v19, v18, s82
    v_xor_b32 v19, s70, v16
    v_bitop3_b32 v19, v19, v17, v18 bitop3:0x96
    buffer_store_dwordx4 v[16:19], v1, s[48:51], s76 offen sc1
L_b_f:
    s_mov_b64 exec, 1
    v_mov_b32 v4, s69
    ds_write_b32 v6, v4 offset:3876
    s_mov_b64 exec, -1
L_b_rd:
    s_mov_b32 s76, 9
    s_cmp_ge_u32 s2, 224
    s_cbranch_scc1 L_fin
    s_mov_b32 s83, 3200000
L_yb_w:
    ds_read_b32 v4, v6 offset:3876
    s_waitcnt lgkmcnt(0)
    v_readfirstlane_b32 s76, v4
    s_sub_u32 s83, s83, 1
    s_cbranch_scc1 L_yb_g
    s_cmp_lg_u32 s76, 0
    s_cbranch_scc1 L_yb_g
    s_sleep 8
    s_branch L_yb_w
L_yb_g:
    s_mov_b32 s69, s76
    v_mov_b32 v76, 0
    v_mov_b32 v77, 0
    v_mov_b32 v78, 0
    v_mov_b32 v80, 0
    v_mov_b32 v81, 0
    v_mov_b32 v82, 0
    v_mov_b32 v84, 0xf149f2ca
    v_mov_b32 v85, 0xf149f2ca
    v_mov_b32 v60, 1.0
    ds_read_b32 v61, v6 offset:3892
    s_mov_b32 s83, 400000
    s_mov_b64 exec, 0xff
    v_mov_b32 v84, 0
L_o_w:
    buffer_load_dwordx4 v[76:79], v1, s[48:51], s73 offen sc1
    s_waitcnt vmcnt(0)
    v_bitop3_b32 v4, v76, v77, v78 bitop3:0x96
    v_xor_b32 v5, s70, v79
    v_cmp_ne_u32 vcc, v4, v5
    s_cbranch_vccz L_o_g
    s_sub_u32 s83, s83, 1
    s_cbranch_scc1 L_o_g
    s_sleep 32
    s_branch L_o_w
L_o_g:
    s_mov_b64 exec, -1
    s_mov_b32 s61, 0
    s_mov_b32 s74, 1
    s_waitcnt lgkmcnt(0)
    s_branch L_t_pg
L_t_a:
    s_mov_b32 s61, 4
    s_mov_b32 s74, 400000
    s_movk_i32 s58, 512
    s_mov_b32 s66, 8
    v_mov_b32 v60, v61
    s_mov_b32 s83, 3200000
L_eb0_w:
    ds_read_b32 v4, v6 offset:3860
    s_waitcnt lgkmcnt(0)
    v_readfirstlane_b32 s76, v4
    s_sub_u32 s83, s83, 1
    s_cbranch_scc1 L_eb0_g
    s_cmp_ge_u32 s76, 1
    s_cbranch_scc1 L_eb0_g
    s_sleep 2
    s_branch L_eb0_w
L_eb0_g:
    buffer_load_dwordx4 v[104:107], v12, s[32:35], 0 offen nt
    s_mov_b32 s83, 3200000
L_eb1_w:
    ds_read_b32 v4, v6 offset:3860
    s_waitcnt lgkmcnt(0)
    v_readfirstlane_b32 s76, v4
    s_sub_u32 s83, s83, 1
    s_cbranch_scc1 L_eb1_g
    s_cmp_ge_u32 s76, 2
    s_cbranch_scc1 L_eb1_g
    s_sleep 2
    s_branch L_eb1_w
L_eb1_g:
    buffer_load_dwordx4 v[108:111], v13, s[32:35], 0 offen nt
    s_mov_b32 s83, 3200000
L_eb2_w:
    ds_read_b32 v4, v6 offset:3860
    s_waitcnt lgkmcnt(0)
    v_readfirstlane_b32 s76, v4
    s_sub_u32 s83, s83, 1
    s_cbranch_scc1 L_eb2_g
    s_cmp_ge_u32 s76, 3
    s_cbranch_scc1 L_eb2_g
    s_sleep 2
    s_branch L_eb2_w
L_eb2_g:
    buffer_load_dwordx4 v[112:115], v14, s[32:35], 0 offen nt
    s_mov_b32 s83, 3200000
L_eb3_w:
    ds_read_b32 v4, v6 offset:3860
    s_waitcnt lgkmcnt(0)
    v_readfirstlane_b32 s76, v4
    s_sub_u32 s83, s83, 1
    s_cbranch_scc1 L_eb3_g
    s_cmp_ge_u32 s76, 4
    s_cbranch_scc1 L_eb3_g
    s_sleep 2
    s_branch L_eb3_w
L_eb3_g:
    buffer_load_dwordx4 v[116:119], v15, s[32:35], 0 offen nt
    s_mov_b32 s83, 3200000
L_eb4_w:
    ds_read_b32 v4, v6 offset:3860
    s_waitcnt lgkmcnt(0)
    v_readfirstlane_b32 s76, v4
    s_sub_u32 s83, s83, 1
    s_cbranch_scc1 L_eb4_g
    s_cmp_ge_u32 s76, 5
    s_cbranch_scc1 L_eb4_g
    s_sleep 2
    s_branch L_eb4_w
L_eb4_g:
    buffer_load_dwordx4 v[136:139], v12, s[44:47], 0 offen nt
    s_mov_b32 s83, 3200000
L_eb5_w:
    ds_read_b32 v4, v6 offset:3860
    s_waitcnt lgkmcnt(0)
    v_readfirstlane_b32 s76, v4
    s_sub_u32 s83, s83, 1
    s_cbranch_scc1 L_eb5_g
    s_cmp_ge_u32 s76, 6
    s_cbranch_scc1 L_eb5_g
    s_sleep 2
    s_branch L_eb5_w
L_eb5_g:
    buffer_load_dwordx4 v[140:143], v13, s[44:47], 0 offen nt
    s_mov_b32 s83, 3200000
L_eb6_w:
    ds_read_b32 v4, v6 offset:3860
    s_waitcnt lgkmcnt(0)
    v_readfirstlane_b32 s76, v4
    s_sub_u32 s83, s83, 1
    s_cbranch_scc1 L_eb6_g
    s_cmp_ge_u32 s76, 7
    s_cbranch_scc1 L_eb6_g
    s_sleep 2
    s_branch L_eb6_w
L_eb6_g:
    buffer_load_dwordx4 v[144:147], v14, s[44:47], 0 offen nt
    s_mov_b32 s83, 3200000
L_eb7_w:
    ds_read_b32 v4, v6 offset:3860
    s_waitcnt lgkmcnt(0)
    v_readfirstlane_b32 s76, v4
    s_sub_u32 s83, s83, 1
    s_cbranch_scc1 L_eb7_g
    s_cmp_ge_u32 s76, 8
    s_cbranch_scc1 L_eb7_g
    s_sleep 2
    s_branch L_eb7_w
L_eb7_g:
    buffer_load_dwordx4 v[148:151], v15, s[44:47], 0 offen nt
    s_waitcnt vmcnt(7)
    v_mfma_f32_16x16x32_bf16 v[72:75], v[32:35], v[104:107], 0
    s_waitcnt vmcnt(6)
    v_mfma_f32_16x16x32_bf16 v[72:75], v[36:39], v[108:111], v[72:75]
    s_waitcnt vmcnt(5)
    v_mfma_f32_16x16x32_bf16 v[72:75], v[40:43], v[112:115], v[72:75]
    s_waitcnt vmcnt(4)
    v_mfma_f32_16x16x32_bf16 v[72:75], v[44:47], v[116:119], v[72:75]
    s_mov_b32 s83, 3200000
L_va_w:
    ds_read_b32 v4, v6 offset:3860
    s_waitcnt lgkmcnt(0)
    v_readfirstlane_b32 s76, v4
    s_sub_u32 s83, s83, 1
    s_cbranch_scc1 L_va_g
    s_cmp_ge_u32 s76, 8
    s_cbranch_scc1 L_va_g
    s_sleep 1
    s_branch L_va_w
L_va_g:
    s_mov_b32 s83, 400000
L_t_pw:
    buffer_load_dwordx4 v[76:79], v70, s[48:51], s62 offen sc1
    buffer_load_dwordx4 v[80:83], v70, s[48:51], s72 offen sc1
L_t_pc:
    s_waitcnt vmcnt(1)
    v_bitop3_b32 v4, v76, v77, v78 bitop3:0x96
    v_xor_b32 v4, v4, v79
    v_mov_b32_dpp v84, v79 quad_perm:[0,0,2,2] row_mask:0xf bank_mask:0xf
    s_waitcnt vmcnt(0)
    v_bitop3_b32 v5, v80, v81, v82 bitop3:0x96
    v_xor_b32 v5, v5, v83
    v_xor_b32_dpp v4, v4, v4 quad_perm:[1,0,3,2] row_mask:0xf bank_mask:0xf
    v_mov_b32_dpp v85, v83 quad_perm:[0,0,2,2] row_mask:0xf bank_mask:0xf
    v_xor_b32_dpp v5, v5, v5 quad_perm:[1,0,3,2] row_mask:0xf bank_mask:0xf
    v_bitop3_b32 v4, v4, v5, s70 bitop3:0x7e
    v_cmp_ne_u32 vcc, 0, v4
    s_cbranch_vccz L_t_pg0
    s_mov_b64 exec, vcc
    s_sub_u32 s83, s83, 1
    s_cbranch_scc0 L_t_pw
L_t_pg0:
    s_mov_b64 exec, -1
L_t_pg:
    v_max_f32 v4, v84, v85
    v_perm_b32 v79, v77, v76, s63
    v_perm_b32 v83, v81, v80, s63
    v_max_f32_dpp v4, v4, v4 row_ror:8 row_mask:0xf bank_mask:0xf
    v_mov_b32 v5, v4
    v_lshl_or_b32 v79, v78, 24, v79
    v_lshl_or_b32 v83, v82, 24, v83
    v_permlane16_swap_b32 v5, v4
    v_max_f32 v4, v5, v4
    v_mov_b32 v5, v4
    s_nop 1
    v_permlane32_swap_b32 v5, v4
    v_max_f32 v4, v5, v4
    v_sub_f32 v24, v84, v4
    v_sub_f32 v26, v85, v4
    v_exp_f32 v24, v24
    v_exp_f32 v26, v26
    v_pk_mul_f32 v[16:17], v[76:77], v[24:25] op_sel_hi:[1,0]
    v_pk_mul_f32 v[18:19], v[78:79], v[24:25] op_sel_hi:[1,0]
    v_add_f32 v28, v24, v26
    v_pk_fma_f32 v[16:17], v[80:81], v[26:27], v[16:17] op_sel_hi:[1,0,1]
    v_pk_fma_f32 v[18:19], v[82:83], v[26:27], v[18:19] op_sel_hi:[1,0,1]
    v_add_f32_dpp v28, v28, v28 row_ror:8 row_mask:0xf bank_mask:0xf
    v_mov_b32 v5, v28
    v_permlane16_swap_b32 v16, v17
    v_permlane16_swap_b32 v18, v19
    v_permlane16_swap_b32 v5, v28
    v_add_f32 v16, v16, v17
    v_add_f32 v18, v18, v19
    v_add_f32 v28, v28, v5
    v_mov_b32 v5, v28
    v_permlane32_swap_b32 v16, v18
    v_add_f32 v16, v16, v18
    v_permlane32_swap_b32 v5, v28
    v_add_f32 v28, v28, v5
    v_add_f32_dpp v16, v16, v16 row_ror:8 row_mask:0xf bank_mask:0xf
    v_rcp_f32 v28, v28
    v_mul_f32 v16, v16, v60
    s_nop 1
    v_mov_b32_dpp v16, v16 row_shr:4 row_mask:0xf bank_mask:0x6
    v_mul_f32 v16, v16, v28
    v_cvt_pk_bf16_f32 v16, v16, v16
    s_nop 1
    v_and_b32_dpp v32, v16, v8 quad_perm:[0,0,0,0] row_mask:0xf bank_mask:0xf
    v_and_b32_dpp v33, v16, v9 quad_perm:[0,0,0,0] row_mask:0xf bank_mask:0xf
    v_and_b32_dpp v34, v16, v10 quad_perm:[0,0,0,0] row_mask:0xf bank_mask:0xf
    v_and_b32_dpp v35, v16, v11 quad_perm:[0,0,0,0] row_mask:0xf bank_mask:0xf
    v_and_b32_dpp v36, v16, v8 quad_perm:[1,1,1,1] row_mask:0xf bank_mask:0xf
    v_and_b32_dpp v37, v16, v9 quad_perm:[1,1,1,1] row_mask:0xf bank_mask:0xf
    v_and_b32_dpp v38, v16, v10 quad_perm:[1,1,1,1] row_mask:0xf bank_mask:0xf
    v_and_b32_dpp v39, v16, v11 quad_perm:[1,1,1,1] row_mask:0xf bank_mask:0xf
    v_mfma_f32_16x16x32_bf16 v[72:75], v[32:35], v[136:139], v[72:75]
    v_and_b32_dpp v40, v16, v8 quad_perm:[2,2,2,2] row_mask:0xf bank_mask:0xf
    v_and_b32_dpp v41, v16, v9 quad_perm:[2,2,2,2] row_mask:0xf bank_mask:0xf
    v_and_b32_dpp v42, v16, v10 quad_perm:[2,2,2,2] row_mask:0xf bank_mask:0xf
    v_and_b32_dpp v43, v16, v11 quad_perm:[2,2,2,2] row_mask:0xf bank_mask:0xf
    v_mfma_f32_16x16x32_bf16 v[72:75], v[36:39], v[140:143], v[72:75]
    v_and_b32_dpp v44, v16, v8 quad_perm:[3,3,3,3] row_mask:0xf bank_mask:0xf
    v_and_b32_dpp v45, v16, v9 quad_perm:[3,3,3,3] row_mask:0xf bank_mask:0xf
    v_and_b32_dpp v46, v16, v10 quad_perm:[3,3,3,3] row_mask:0xf bank_mask:0xf
    v_and_b32_dpp v47, v16, v11 quad_perm:[3,3,3,3] row_mask:0xf bank_mask:0xf
    v_mfma_f32_16x16x32_bf16 v[72:75], v[40:43], v[144:147], v[72:75]
    s_nop 0
    v_mfma_f32_16x16x32_bf16 v[72:75], v[44:47], v[148:151], v[72:75]
    s_mov_b32 exec_lo, 0x00ff00ff
    s_mov_b32 exec_hi, 0xff00ff00
    s_nop 5
    ds_write_b128 v65, v[72:75] offset:1536
    s_mov_b64 exec, 1
    ds_add_rtn_u32 v4, v6, v7 offset:3888
    s_mov_b32 exec_lo, -1
    ds_read_b128 v[16:19], v1 offset:1536
    ds_read_b128 v[20:23], v1 offset:2048
    ds_read_b128 v[24:27], v1 offset:2560
    ds_read_b128 v[28:31], v1 offset:3072
    s_waitcnt lgkmcnt(0)
    v_readfirstlane_b32 s76, v4
    v_pk_add_f32 v[16:17], v[16:17], v[20:21]
    v_pk_add_f32 v[18:19], v[18:19], v[22:23]
    v_pk_add_f32 v[24:25], v[24:25], v[28:29]
    v_pk_add_f32 v[26:27], v[26:27], v[30:31]
    s_sub_u32 s76, s76, s61
    s_cmp_lg_u32 s76, 3
    s_cbranch_scc1 L_t_nst
    v_pk_add_f32 v[16:17], v[16:17], v[24:25]
    v_pk_add_f32 v[18:19], v[18:19], v[26:27]
    v_perm_b32 v16, v19, v16, s80
    v_perm_b32 v17, v19, v17, s81
    v_perm_b32 v18, v19, v18, s82
    s_cmp_eq_u32 s69, 1
    v_xor_b32 v19, s70, v16
    v_bitop3_b32 v19, v19, v17, v18 bitop3:0x96
    s_cbranch_scc0 L_t_yg2
    buffer_store_dwordx4 v[16:19], v1, s[56:59], 0 offen
L_t_ys:
L_t_nst:
    s_mov_b64 exec, -1
    s_cmp_lg_u32 s76, 0
    s_cbranch_scc1 L_t_next
    s_bitcmp1_b32 s2, 0
    s_cbranch_scc1 L_t_next
    s_mov_b32 s83, s74
L_t_yw:
    buffer_load_dwordx4 v[16:19], v64, s[48:51], s60 offen sc1
    s_waitcnt vmcnt(0)
    v_bitop3_b32 v4, v16, v17, v18 bitop3:0x96
    v_xor_b32 v5, s70, v19
    v_perm_b32 v19, v17, v16, s63
    v_cmp_ne_u32 vcc, v4, v5
    v_lshl_or_b32 v19, v18, 24, v19
    s_cbranch_vccz L_t_yg
    s_mov_b64 exec, vcc
    s_sub_u32 s83, s83, 1
    s_cmp_lg_u32 s83, 0
    s_cbranch_scc1 L_t_yw
L_t_yg:
    s_mov_b64 exec, -1
    v_permlane16_swap_b32 v16, v17
    v_permlane16_swap_b32 v18, v19
    v_add_f32 v16, v16, v17
    v_add_f32 v18, v18, v19
    s_nop 1
    v_permlane32_swap_b32 v16, v18
    v_add_f32 v16, v16, v18
    s_nop 1
    v_add_f32_dpp v16, v16, v16 quad_perm:[1,0,3,2] row_mask:0xf bank_mask:0xf
    s_nop 1
    v_add_f32_dpp v16, v16, v16 quad_perm:[2,3,0,1] row_mask:0xf bank_mask:0xf
    s_nop 1
    v_add_f32_dpp v16, v16, v16 row_half_mirror row_mask:0xf bank_mask:0xf
    s_nop 1
    v_add_f32_dpp v16, v16, v16 row_mirror row_mask:0xf bank_mask:0xf
    v_cvt_pk_bf16_f32 v16, v16, v16
    buffer_store_short v16, v62, s[64:67], 0 offen
    s_cmp_eq_u32 s61, 0
    s_cbranch_scc1 L_t_next
    s_cmp_lg_u32 s2, 0
    s_cbranch_scc1 L_t_next
    v_mov_b32 v4, s70
    v_mov_b32 v5, 0x8000
    s_mov_b64 exec, 1
    buffer_store_dword v4, v5, s[48:51], 0 offen sc1
    s_mov_b64 exec, -1
L_t_next:
    s_cmp_lg_u32 s61, 0
    s_cbranch_scc1 L_fin
    s_mov_b32 s83, 3200000
L_y4_w:
    ds_read_b32 v4, v6 offset:3888
    s_waitcnt lgkmcnt(0)
    v_readfirstlane_b32 s76, v4
    s_sub_u32 s83, s83, 1
    s_cbranch_scc1 L_y4_g
    s_cmp_ge_u32 s76, 4
    s_cbranch_scc1 L_y4_g
    s_sleep 2
    s_branch L_y4_w
L_y4_g:
    s_branch L_t_a
L_t_yg2:
    buffer_store_dwordx4 v[16:19], v1, s[56:59], 0 offen sc1
    s_branch L_t_ys
L_fin:
    s_endpgm
L_end:
    s_endpgm
L_code_end:
.section .rodata,"a"
.p2align 6
.amdhsa_kernel gated_mix__mha_block_cached__gqa_block_cached__decode_kernel
  .amdhsa_next_free_vgpr 168
  .amdhsa_next_free_sgpr 102
  .amdhsa_accum_offset 168
  .amdhsa_group_segment_fixed_size 0
  .amdhsa_kernarg_size 112
  .amdhsa_user_sgpr_count 2
  .amdhsa_user_sgpr_kernarg_segment_ptr 1
  .amdhsa_system_sgpr_workgroup_id_x 1
.end_amdhsa_kernel
```
